```python
import torch

def _softmax(x, axis=-1):
    return torch.softmax(x, dim=axis)
def _gelu(x):
    return torch.nn.functional.gelu(x, approximate="tanh")
def _silu(x):
    return torch.nn.functional.silu(x)
def _sigmoid(x):
    return torch.sigmoid(x)
def _layernorm(x, axis=-1, eps=1e-5):
    m = x.mean(dim=axis, keepdim=True)
    v = x.var(dim=axis, keepdim=True, unbiased=False)
    return (x - m) / torch.sqrt(v + eps)
def _scatter_add(tgt, idx, src, axis=0):
    return tgt.clone().index_add_(axis, idx, src)
def _segment_sum(src, seg, n):
    out = torch.zeros((n,) + src.shape[1:], dtype=src.dtype)
    return out.index_add_(0, seg, src)
def _pad(x, pw):
    flat = tuple(v for pair in reversed(pw) for v in pair)
    return torch.nn.functional.pad(x, flat)

kernel_name = 'sequential_preLN__sliding_block_cached__glu_gated_reglu__decode'

def setup_inputs():

    _w = (lambda a: (lambda t: t.to(torch.bfloat16) if t.is_floating_point() else t)(torch.as_tensor(a)))
    def _A_setup():
        B, Sq, D = 1, 1, 576
        Hq, Hkv, Sk, Dh = 32, 16, 65536, 128
        assert Hq % Hkv == 0, (Hq, Hkv)
        return {
            "x": _w((lambda *s: torch.randn(*s, dtype=torch.bfloat16) * 0.05)(B, Sq, D)),
            "k_cache": _w((lambda *s: torch.randn(*s, dtype=torch.bfloat16) * 1.6)(B, Hkv, Sk, Dh)),
            "v_cache": _w((lambda *s: torch.randn(*s, dtype=torch.bfloat16) * 0.8)(B, Hkv, Sk, Dh)),
            "wq": _w((lambda *s: torch.randn(*s, dtype=torch.bfloat16) * 1.6)(D, Hq * Dh) * (D ** -0.5)),
            "wo": _w((lambda *s: torch.randn(*s, dtype=torch.bfloat16) * 0.8)(Hq * Dh, D) * ((Hq * Dh) ** -0.5)),
        }
    _A_in = _A_setup()

    def _B_setup():
        B, S, D, F = 1, 1, 576, 4608
        return {
            "x": _w((lambda *s: torch.randn(*s, dtype=torch.bfloat16) * 0.05)(B, S, D)),
            "W_gate": _w((lambda *s: torch.randn(*s, dtype=torch.bfloat16) * 0.4)(D, F) * (2.0 / D) ** 0.5),
            "W_up": _w((lambda *s: torch.randn(*s, dtype=torch.bfloat16) * 0.4)(D, F) * (2.0 / D) ** 0.5),
            "W_down": _w((lambda *s: torch.randn(*s, dtype=torch.bfloat16) * 0.4)(F, D) * (1.0 / F) ** 0.5),
        }
    _B_in = _B_setup()

    return {
        "A_x": _A_in["x"],
        "A_k_cache": _A_in["k_cache"],
        "A_v_cache": _A_in["v_cache"],
        "A_wq": _A_in["wq"],
        "A_wo": _A_in["wo"],
        "B_x": _B_in["x"],
        "B_W_gate": _B_in["W_gate"],
        "B_W_up": _B_in["W_up"],
        "B_W_down": _B_in["W_down"],
    }

def reference(A_x, A_k_cache, A_v_cache, A_wq, A_wo, B_x, B_W_gate, B_W_up, B_W_down):
    def _A_ref(x, k_cache, v_cache, wq, wo):
        B, Sq, D = x.shape
        Hq, Dh = 32, 128
        Hkv, Sk = k_cache.shape[1], k_cache.shape[2]
        W = min(4096, max(256, Sk // 4))
        rep = Hq // Hkv
        q = (lambda x, *d: x.permute(*d))((x @ wq).reshape(B, Sq, Hq, Dh), 0, 2, 1, 3)
        k = (lambda x, n, axis: torch.repeat_interleave(x, n, dim=axis))(k_cache[:, :, Sk - W:, :], rep, axis=1)
        v = (lambda x, n, axis: torch.repeat_interleave(x, n, dim=axis))(v_cache[:, :, Sk - W:, :], rep, axis=1)
        scores = torch.einsum("bhqd,bhkd->bhqk", q, k) * (Dh ** -0.5)
        p = _softmax(scores, axis=-1)
        o = torch.einsum("bhqk,bhkd->bhqd", p, v)
        return (lambda x, *d: x.permute(*d))(o, 0, 2, 1, 3).reshape(B, Sq, Hq * Dh) @ wo

    def _B_ref(x, W_gate, W_up, W_down):
        gate = torch.einsum("bsd,df->bsf", x, W_gate)
        up = torch.einsum("bsd,df->bsf", x, W_up)
        gate = gate * (lambda x, dt: x.to(dt))(gate > 0, gate.dtype)
        h = gate * up
        return torch.einsum("bsf,fd->bsd", h, W_down)

    x = A_x
    h = x + _A_ref(_layernorm(x, axis=-1), A_k_cache, A_v_cache, A_wq, A_wo)
    h2 = h + _B_ref(_layernorm(h, axis=-1), B_W_gate, B_W_up, B_W_down)
    return h2
```

```asm
; @launch grid=(256,1,1) block=(320,1,1) lds=161280
.amdgcn_target "amdgcn-amd-amdhsa--gfx950"
.text
.globl sequential_preLN__sliding_block_cached__glu_gated_reglu__decode_kernel
.p2align 8
.type sequential_preLN__sliding_block_cached__glu_gated_reglu__decode_kernel,@function
sequential_preLN__sliding_block_cached__glu_gated_reglu__decode_kernel:
KSTART:
    s_cmp_ge_u32 s2, 256
    s_cbranch_scc1 L_exit
    s_load_dwordx16 s[4:19], s[0:1], 0
    s_load_dwordx8 s[20:27], s[0:1], 64
    v_and_b32 v1, 63, v0
    v_lshrrev_b32 v2, 6, v0
    s_and_b32 s28, s2, 7
    s_lshl_b32 s28, s28, 1
    s_lshr_b32 s29, s2, 3
    s_and_b32 s29, s29, 1
    s_or_b32 s28, s28, s29
    s_lshr_b32 s29, s2, 4
    v_readfirstlane_b32 s3, v2
    v_lshrrev_b32 v20, 3, v1
    v_lshlrev_b32 v20, 13, v20
    v_and_b32 v21, 7, v1
    v_lshlrev_b32 v21, 4, v21
    v_add_u32 v5, v20, v21
    s_lshr_b32 s40, s29, 2
    s_mul_i32 s40, s40, 1179648
    s_and_b32 s41, s29, 3
    s_lshl_b32 s41, s41, 7
    s_lshl_b32 s42, s28, 9
    s_add_u32 s41, s41, s42
    s_add_u32 s40, s40, s41
    s_sub_u32 s34, 4718592, s40
    s_mov_b32 s35, 0x20000
    s_mov_b32 m0, 0
    s_mov_b32 s36, 0
    s_waitcnt lgkmcnt(0)
    s_cmp_lg_u32 s3, 0
    s_cbranch_scc1 L_consumer
L_loader:
    s_add_u32 s32, s10, s40
    s_addc_u32 s33, s11, 0
    buffer_load_dwordx4 v5, s[32:35], s36 offen nt lds
    s_setprio 1
    s_load_dword s58, s[26:27], 258048
    v_lshlrev_b32 v4, 4, v1
    s_add_u32 m0, m0, 0x400
    s_add_u32 s36, s36, 0x10000
    buffer_load_dwordx4 v5, s[32:35], s36 offen nt lds
    v_lshrrev_b32 v20, 4, v1
    v_lshlrev_b32 v21, 2, v20
    v_and_b32 v22, 15, v1
    v_xor_b32 v22, v22, v21
    v_lshlrev_b32 v20, 8, v20
    v_xor_b32 v23, 0, v22
    v_lshlrev_b32 v23, 4, v23
    v_add_u32 v6, v20, v23
    v_xor_b32 v23, 1, v22
    v_lshlrev_b32 v23, 4, v23
    v_add_u32 v7, v20, v23
    v_xor_b32 v23, 2, v22
    v_lshlrev_b32 v23, 4, v23
    v_add_u32 v8, v20, v23
    v_xor_b32 v23, 3, v22
    v_lshlrev_b32 v23, 4, v23
    v_add_u32 v9, v20, v23
    v_mov_b32 v16, 158016
    s_add_u32 m0, m0, 0x400
    s_add_u32 s36, s36, 0x10000
    buffer_load_dwordx4 v5, s[32:35], s36 offen nt lds
    s_add_u32 m0, m0, 0x400
    s_add_u32 s36, s36, 0x10000
    buffer_load_dwordx4 v5, s[32:35], s36 offen nt lds
    s_add_u32 m0, m0, 0x400
    s_add_u32 s36, s36, 0x10000
    buffer_load_dwordx4 v5, s[32:35], s36 offen nt lds
    s_add_u32 m0, m0, 0x400
    s_add_u32 s36, s36, 0x10000
    buffer_load_dwordx4 v5, s[32:35], s36 offen nt lds
    s_add_u32 m0, m0, 0x400
    s_add_u32 s36, s36, 0x10000
    buffer_load_dwordx4 v5, s[32:35], s36 offen nt lds
    s_add_u32 m0, m0, 0x400
    s_add_u32 s36, s36, 0x10000
    buffer_load_dwordx4 v5, s[32:35], s36 offen nt lds
    s_add_u32 m0, m0, 0x400
    s_add_u32 s36, s36, 0x10000
    buffer_load_dwordx4 v5, s[32:35], s36 offen nt lds
    s_add_u32 m0, m0, 0x400
    s_add_u32 s36, s36, 0x10000
    buffer_load_dwordx4 v5, s[32:35], s36 offen nt lds
    s_add_u32 m0, m0, 0x400
    s_add_u32 s36, s36, 0x10000
    buffer_load_dwordx4 v5, s[32:35], s36 offen nt lds
    s_add_u32 m0, m0, 0x400
    s_add_u32 s36, s36, 0x10000
    buffer_load_dwordx4 v5, s[32:35], s36 offen nt lds
    s_add_u32 m0, m0, 0x400
    s_add_u32 s36, s36, 0x10000
    buffer_load_dwordx4 v5, s[32:35], s36 offen nt lds
    s_add_u32 m0, m0, 0x400
    s_add_u32 s36, s36, 0x10000
    buffer_load_dwordx4 v5, s[32:35], s36 offen nt lds
    s_add_u32 m0, m0, 0x400
    s_add_u32 s36, s36, 0x10000
    buffer_load_dwordx4 v5, s[32:35], s36 offen nt lds
    s_add_u32 m0, m0, 0x400
    s_add_u32 s36, s36, 0x10000
    buffer_load_dwordx4 v5, s[32:35], s36 offen nt lds
    s_add_u32 m0, m0, 0x400
    s_add_u32 s36, s36, 0x10000
    buffer_load_dwordx4 v5, s[32:35], s36 offen nt lds
    s_add_u32 m0, m0, 0x400
    s_add_u32 s36, s36, 0x10000
    buffer_load_dwordx4 v5, s[32:35], s36 offen nt lds
    s_lshl_b32 s40, s28, 24
    s_lshl_b32 s42, s29, 16
    s_add_u32 s42, s42, 15728640
    s_add_u32 s40, s40, s42
    s_add_u32 s32, s6, s40
    s_addc_u32 s33, s7, 0
    s_mov_b32 s34, 65536
    s_mov_b32 m0, 18432
    s_mov_b32 s36, 0
    s_mul_i32 s36, s28, 5
    s_add_u32 s36, s36, s29
    s_and_b32 s36, s36, 15
    s_lshl_b32 s36, s36, 12
    s_nop 0
    buffer_load_dwordx4 v6, s[32:35], s36 offen nt lds
    buffer_load_dwordx4 v7, s[32:35], s36 offen offset:1024 nt lds
    buffer_load_dwordx4 v8, s[32:35], s36 offen offset:2048 nt lds
    buffer_load_dwordx4 v9, s[32:35], s36 offen offset:3072 nt lds
    s_barrier
    s_waitcnt vmcnt(21)
    s_add_u32 m0, m0, 0x1000
    s_add_u32 s36, s36, 0x1000
    s_and_b32 s36, s36, 0xffff
    buffer_load_dwordx4 v6, s[32:35], s36 offen nt lds
    s_waitcnt vmcnt(21)
    buffer_load_dwordx4 v7, s[32:35], s36 offen offset:1024 nt lds
    s_waitcnt vmcnt(21)
    buffer_load_dwordx4 v8, s[32:35], s36 offen offset:2048 nt lds
    s_waitcnt vmcnt(21)
    buffer_load_dwordx4 v9, s[32:35], s36 offen offset:3072 nt lds
    s_waitcnt vmcnt(21)
    s_add_u32 m0, m0, 0x1000
    s_add_u32 s36, s36, 0x1000
    s_and_b32 s36, s36, 0xffff
    buffer_load_dwordx4 v6, s[32:35], s36 offen nt lds
    s_waitcnt vmcnt(21)
    buffer_load_dwordx4 v7, s[32:35], s36 offen offset:1024 nt lds
    s_waitcnt vmcnt(21)
    buffer_load_dwordx4 v8, s[32:35], s36 offen offset:2048 nt lds
    s_waitcnt vmcnt(21)
    buffer_load_dwordx4 v9, s[32:35], s36 offen offset:3072 nt lds
    s_waitcnt vmcnt(21)
    s_add_u32 m0, m0, 0x1000
    s_add_u32 s36, s36, 0x1000
    s_and_b32 s36, s36, 0xffff
    buffer_load_dwordx4 v6, s[32:35], s36 offen nt lds
    s_waitcnt vmcnt(21)
    buffer_load_dwordx4 v7, s[32:35], s36 offen offset:1024 nt lds
    s_waitcnt vmcnt(21)
    buffer_load_dwordx4 v8, s[32:35], s36 offen offset:2048 nt lds
    s_waitcnt vmcnt(21)
    buffer_load_dwordx4 v9, s[32:35], s36 offen offset:3072 nt lds
    s_waitcnt vmcnt(21)
    s_add_u32 m0, m0, 0x1000
    s_add_u32 s36, s36, 0x1000
    s_and_b32 s36, s36, 0xffff
    buffer_load_dwordx4 v6, s[32:35], s36 offen nt lds
    s_waitcnt vmcnt(21)
    buffer_load_dwordx4 v7, s[32:35], s36 offen offset:1024 nt lds
    s_waitcnt vmcnt(21)
    buffer_load_dwordx4 v8, s[32:35], s36 offen offset:2048 nt lds
    s_waitcnt vmcnt(21)
    buffer_load_dwordx4 v9, s[32:35], s36 offen offset:3072 nt lds
    s_waitcnt vmcnt(21)
    s_add_u32 m0, m0, 0x1000
    s_add_u32 s36, s36, 0x1000
    s_and_b32 s36, s36, 0xffff
    buffer_load_dwordx4 v6, s[32:35], s36 offen nt lds
    s_waitcnt vmcnt(21)
    v_mov_b32 v17, 1
    s_mov_b64 exec, 1
    ds_write_b32 v16, v17 offset:0
    s_mov_b64 exec, -1
    buffer_load_dwordx4 v7, s[32:35], s36 offen offset:1024 nt lds
    s_waitcnt vmcnt(21)
    buffer_load_dwordx4 v8, s[32:35], s36 offen offset:2048 nt lds
    s_waitcnt vmcnt(21)
    buffer_load_dwordx4 v9, s[32:35], s36 offen offset:3072 nt lds
    s_waitcnt vmcnt(21)
    s_add_u32 m0, m0, 0x1000
    s_add_u32 s36, s36, 0x1000
    s_and_b32 s36, s36, 0xffff
    buffer_load_dwordx4 v6, s[32:35], s36 offen nt lds
    s_waitcnt vmcnt(21)
    buffer_load_dwordx4 v7, s[32:35], s36 offen offset:1024 nt lds
    s_waitcnt vmcnt(21)
    buffer_load_dwordx4 v8, s[32:35], s36 offen offset:2048 nt lds
    s_waitcnt vmcnt(21)
    buffer_load_dwordx4 v9, s[32:35], s36 offen offset:3072 nt lds
    s_waitcnt vmcnt(21)
    s_add_u32 m0, m0, 0x1000
    s_add_u32 s36, s36, 0x1000
    s_and_b32 s36, s36, 0xffff
    buffer_load_dwordx4 v6, s[32:35], s36 offen nt lds
    s_waitcnt vmcnt(21)
    buffer_load_dwordx4 v7, s[32:35], s36 offen offset:1024 nt lds
    s_waitcnt vmcnt(21)
    buffer_load_dwordx4 v8, s[32:35], s36 offen offset:2048 nt lds
    s_waitcnt vmcnt(21)
    buffer_load_dwordx4 v9, s[32:35], s36 offen offset:3072 nt lds
    s_waitcnt vmcnt(21)
    s_add_u32 m0, m0, 0x1000
    s_add_u32 s36, s36, 0x1000
    s_and_b32 s36, s36, 0xffff
    buffer_load_dwordx4 v6, s[32:35], s36 offen nt lds
    s_waitcnt vmcnt(21)
    buffer_load_dwordx4 v7, s[32:35], s36 offen offset:1024 nt lds
    s_waitcnt vmcnt(21)
    buffer_load_dwordx4 v8, s[32:35], s36 offen offset:2048 nt lds
    s_waitcnt vmcnt(21)
    buffer_load_dwordx4 v9, s[32:35], s36 offen offset:3072 nt lds
    s_waitcnt vmcnt(21)
    s_add_u32 m0, m0, 0x1000
    s_add_u32 s36, s36, 0x1000
    s_and_b32 s36, s36, 0xffff
    buffer_load_dwordx4 v6, s[32:35], s36 offen nt lds
    s_waitcnt vmcnt(21)
    v_mov_b32 v17, 2
    s_mov_b64 exec, 1
    ds_write_b32 v16, v17 offset:0
    s_mov_b64 exec, -1
    buffer_load_dwordx4 v7, s[32:35], s36 offen offset:1024 nt lds
    s_waitcnt vmcnt(21)
    buffer_load_dwordx4 v8, s[32:35], s36 offen offset:2048 nt lds
    s_waitcnt vmcnt(21)
    buffer_load_dwordx4 v9, s[32:35], s36 offen offset:3072 nt lds
    s_waitcnt vmcnt(21)
    s_add_u32 m0, m0, 0x1000
    s_add_u32 s36, s36, 0x1000
    s_and_b32 s36, s36, 0xffff
    buffer_load_dwordx4 v6, s[32:35], s36 offen nt lds
    s_waitcnt vmcnt(21)
    buffer_load_dwordx4 v7, s[32:35], s36 offen offset:1024 nt lds
    s_waitcnt vmcnt(21)
    buffer_load_dwordx4 v8, s[32:35], s36 offen offset:2048 nt lds
    s_waitcnt vmcnt(21)
    buffer_load_dwordx4 v9, s[32:35], s36 offen offset:3072 nt lds
    s_waitcnt vmcnt(21)
    s_add_u32 m0, m0, 0x1000
    s_add_u32 s36, s36, 0x1000
    s_and_b32 s36, s36, 0xffff
    buffer_load_dwordx4 v6, s[32:35], s36 offen nt lds
    s_waitcnt vmcnt(21)
    buffer_load_dwordx4 v7, s[32:35], s36 offen offset:1024 nt lds
    s_waitcnt vmcnt(21)
    v_mov_b32 v17, 1
    s_mov_b64 exec, 1
    ds_write_b32 v16, v17 offset:24
    s_mov_b64 exec, -1
    buffer_load_dwordx4 v8, s[32:35], s36 offen offset:2048 nt lds
    s_waitcnt vmcnt(21)
    buffer_load_dwordx4 v9, s[32:35], s36 offen offset:3072 nt lds
    s_waitcnt vmcnt(21)
    s_add_u32 m0, m0, 0x1000
    s_add_u32 s36, s36, 0x1000
    s_and_b32 s36, s36, 0xffff
    buffer_load_dwordx4 v6, s[32:35], s36 offen nt lds
    s_waitcnt vmcnt(21)
    buffer_load_dwordx4 v7, s[32:35], s36 offen offset:1024 nt lds
    s_waitcnt vmcnt(21)
    buffer_load_dwordx4 v8, s[32:35], s36 offen offset:2048 nt lds
    s_waitcnt vmcnt(21)
    buffer_load_dwordx4 v9, s[32:35], s36 offen offset:3072 nt lds
    s_waitcnt vmcnt(21)
    s_add_u32 m0, m0, 0x1000
    s_add_u32 s36, s36, 0x1000
    s_and_b32 s36, s36, 0xffff
    buffer_load_dwordx4 v6, s[32:35], s36 offen nt lds
    s_waitcnt vmcnt(21)
    v_mov_b32 v17, 3
    s_mov_b64 exec, 1
    ds_write_b32 v16, v17 offset:0
    s_mov_b64 exec, -1
    buffer_load_dwordx4 v7, s[32:35], s36 offen offset:1024 nt lds
    s_waitcnt vmcnt(21)
    buffer_load_dwordx4 v8, s[32:35], s36 offen offset:2048 nt lds
    s_waitcnt vmcnt(21)
    buffer_load_dwordx4 v9, s[32:35], s36 offen offset:3072 nt lds
    s_waitcnt vmcnt(21)
    s_add_u32 m0, m0, 0x1000
    s_add_u32 s36, s36, 0x1000
    s_and_b32 s36, s36, 0xffff
    buffer_load_dwordx4 v6, s[32:35], s36 offen nt lds
    s_waitcnt vmcnt(21)
    buffer_load_dwordx4 v7, s[32:35], s36 offen offset:1024 nt lds
    s_waitcnt vmcnt(21)
    buffer_load_dwordx4 v8, s[32:35], s36 offen offset:2048 nt lds
    s_waitcnt vmcnt(21)
    buffer_load_dwordx4 v9, s[32:35], s36 offen offset:3072 nt lds
    s_waitcnt vmcnt(21)
    s_add_u32 m0, m0, 0x1000
    s_add_u32 s36, s36, 0x1000
    s_and_b32 s36, s36, 0xffff
    buffer_load_dwordx4 v6, s[32:35], s36 offen nt lds
    s_waitcnt vmcnt(21)
    buffer_load_dwordx4 v7, s[32:35], s36 offen offset:1024 nt lds
    s_waitcnt vmcnt(21)
    buffer_load_dwordx4 v8, s[32:35], s36 offen offset:2048 nt lds
    s_waitcnt vmcnt(21)
    buffer_load_dwordx4 v9, s[32:35], s36 offen offset:3072 nt lds
    s_waitcnt vmcnt(21)
    s_lshl_b32 s40, s28, 24
    s_lshl_b32 s42, s29, 16
    s_add_u32 s42, s42, 15728640
    s_add_u32 s40, s40, s42
    s_add_u32 s32, s8, s40
    s_addc_u32 s33, s9, 0
    s_mov_b32 s34, 65536
    s_mov_b32 m0, 83968
    s_mov_b32 s36, 0
    s_mul_i32 s36, s28, 5
    s_add_u32 s36, s36, s29
    s_and_b32 s36, s36, 15
    s_lshl_b32 s36, s36, 12
    s_nop 0
    buffer_load_dwordx4 v4, s[32:35], s36 offen nt lds
    s_waitcnt vmcnt(21)
    buffer_load_dwordx4 v4, s[32:35], s36 offen offset:1024 nt lds
    s_waitcnt vmcnt(21)
    buffer_load_dwordx4 v4, s[32:35], s36 offen offset:2048 nt lds
    s_waitcnt vmcnt(21)
    buffer_load_dwordx4 v4, s[32:35], s36 offen offset:3072 nt lds
    s_waitcnt vmcnt(21)
    s_add_u32 m0, m0, 0x1000
    s_add_u32 s36, s36, 0x1000
    s_and_b32 s36, s36, 0xffff
    buffer_load_dwordx4 v4, s[32:35], s36 offen nt lds
    s_waitcnt vmcnt(21)
    v_mov_b32 v17, 4
    s_mov_b64 exec, 1
    ds_write_b32 v16, v17 offset:0
    s_mov_b64 exec, -1
    buffer_load_dwordx4 v4, s[32:35], s36 offen offset:1024 nt lds
    s_waitcnt vmcnt(21)
    buffer_load_dwordx4 v4, s[32:35], s36 offen offset:2048 nt lds
    s_waitcnt vmcnt(21)
    buffer_load_dwordx4 v4, s[32:35], s36 offen offset:3072 nt lds
    s_waitcnt vmcnt(21)
    s_add_u32 m0, m0, 0x1000
    s_add_u32 s36, s36, 0x1000
    s_and_b32 s36, s36, 0xffff
    buffer_load_dwordx4 v4, s[32:35], s36 offen nt lds
    s_waitcnt vmcnt(21)
    buffer_load_dwordx4 v4, s[32:35], s36 offen offset:1024 nt lds
    s_waitcnt vmcnt(21)
    buffer_load_dwordx4 v4, s[32:35], s36 offen offset:2048 nt lds
    s_waitcnt vmcnt(21)
    buffer_load_dwordx4 v4, s[32:35], s36 offen offset:3072 nt lds
    s_waitcnt vmcnt(21)
    s_add_u32 m0, m0, 0x1000
    s_add_u32 s36, s36, 0x1000
    s_and_b32 s36, s36, 0xffff
    buffer_load_dwordx4 v4, s[32:35], s36 offen nt lds
    s_waitcnt vmcnt(21)
    buffer_load_dwordx4 v4, s[32:35], s36 offen offset:1024 nt lds
    s_waitcnt vmcnt(21)
    buffer_load_dwordx4 v4, s[32:35], s36 offen offset:2048 nt lds
    s_waitcnt vmcnt(21)
    buffer_load_dwordx4 v4, s[32:35], s36 offen offset:3072 nt lds
    s_waitcnt vmcnt(21)
    s_add_u32 m0, m0, 0x1000
    s_add_u32 s36, s36, 0x1000
    s_and_b32 s36, s36, 0xffff
    buffer_load_dwordx4 v4, s[32:35], s36 offen nt lds
    s_waitcnt vmcnt(21)
    buffer_load_dwordx4 v4, s[32:35], s36 offen offset:1024 nt lds
    s_waitcnt vmcnt(21)
    buffer_load_dwordx4 v4, s[32:35], s36 offen offset:2048 nt lds
    s_waitcnt vmcnt(21)
    buffer_load_dwordx4 v4, s[32:35], s36 offen offset:3072 nt lds
    s_waitcnt vmcnt(21)
    s_add_u32 m0, m0, 0x1000
    s_add_u32 s36, s36, 0x1000
    s_and_b32 s36, s36, 0xffff
    buffer_load_dwordx4 v4, s[32:35], s36 offen nt lds
    s_waitcnt vmcnt(21)
    v_mov_b32 v17, 5
    s_mov_b64 exec, 1
    ds_write_b32 v16, v17 offset:0
    s_mov_b64 exec, -1
    buffer_load_dwordx4 v4, s[32:35], s36 offen offset:1024 nt lds
    s_waitcnt vmcnt(21)
    buffer_load_dwordx4 v4, s[32:35], s36 offen offset:2048 nt lds
    s_waitcnt vmcnt(21)
    buffer_load_dwordx4 v4, s[32:35], s36 offen offset:3072 nt lds
    s_waitcnt vmcnt(21)
    s_add_u32 m0, m0, 0x1000
    s_add_u32 s36, s36, 0x1000
    s_and_b32 s36, s36, 0xffff
    buffer_load_dwordx4 v4, s[32:35], s36 offen nt lds
    s_waitcnt vmcnt(21)
    buffer_load_dwordx4 v4, s[32:35], s36 offen offset:1024 nt lds
    s_waitcnt vmcnt(21)
    buffer_load_dwordx4 v4, s[32:35], s36 offen offset:2048 nt lds
    s_waitcnt vmcnt(21)
    buffer_load_dwordx4 v4, s[32:35], s36 offen offset:3072 nt lds
    s_waitcnt vmcnt(21)
    s_add_u32 m0, m0, 0x1000
    s_add_u32 s36, s36, 0x1000
    s_and_b32 s36, s36, 0xffff
    buffer_load_dwordx4 v4, s[32:35], s36 offen nt lds
    s_waitcnt vmcnt(21)
    buffer_load_dwordx4 v4, s[32:35], s36 offen offset:1024 nt lds
    s_waitcnt vmcnt(21)
    buffer_load_dwordx4 v4, s[32:35], s36 offen offset:2048 nt lds
    s_waitcnt vmcnt(21)
    buffer_load_dwordx4 v4, s[32:35], s36 offen offset:3072 nt lds
    s_waitcnt vmcnt(21)
    s_add_u32 m0, m0, 0x1000
    s_add_u32 s36, s36, 0x1000
    s_and_b32 s36, s36, 0xffff
    buffer_load_dwordx4 v4, s[32:35], s36 offen nt lds
    s_waitcnt vmcnt(21)
    buffer_load_dwordx4 v4, s[32:35], s36 offen offset:1024 nt lds
    s_waitcnt vmcnt(21)
    buffer_load_dwordx4 v4, s[32:35], s36 offen offset:2048 nt lds
    s_waitcnt vmcnt(21)
    buffer_load_dwordx4 v4, s[32:35], s36 offen offset:3072 nt lds
    s_waitcnt vmcnt(21)
    s_add_u32 m0, m0, 0x1000
    s_add_u32 s36, s36, 0x1000
    s_and_b32 s36, s36, 0xffff
    buffer_load_dwordx4 v4, s[32:35], s36 offen nt lds
    s_waitcnt vmcnt(21)
    v_mov_b32 v17, 6
    s_mov_b64 exec, 1
    ds_write_b32 v16, v17 offset:0
    s_mov_b64 exec, -1
    buffer_load_dwordx4 v4, s[32:35], s36 offen offset:1024 nt lds
    s_waitcnt vmcnt(21)
    buffer_load_dwordx4 v4, s[32:35], s36 offen offset:2048 nt lds
    s_waitcnt vmcnt(21)
    buffer_load_dwordx4 v4, s[32:35], s36 offen offset:3072 nt lds
    s_waitcnt vmcnt(21)
    s_add_u32 m0, m0, 0x1000
    s_add_u32 s36, s36, 0x1000
    s_and_b32 s36, s36, 0xffff
    buffer_load_dwordx4 v4, s[32:35], s36 offen nt lds
    s_waitcnt vmcnt(21)
    buffer_load_dwordx4 v4, s[32:35], s36 offen offset:1024 nt lds
    s_waitcnt vmcnt(21)
    buffer_load_dwordx4 v4, s[32:35], s36 offen offset:2048 nt lds
    s_waitcnt vmcnt(21)
    buffer_load_dwordx4 v4, s[32:35], s36 offen offset:3072 nt lds
    s_waitcnt vmcnt(21)
    s_add_u32 m0, m0, 0x1000
    s_add_u32 s36, s36, 0x1000
    s_and_b32 s36, s36, 0xffff
    buffer_load_dwordx4 v4, s[32:35], s36 offen nt lds
    s_waitcnt vmcnt(21)
    buffer_load_dwordx4 v4, s[32:35], s36 offen offset:1024 nt lds
    s_waitcnt vmcnt(21)
    buffer_load_dwordx4 v4, s[32:35], s36 offen offset:2048 nt lds
    s_waitcnt vmcnt(21)
    buffer_load_dwordx4 v4, s[32:35], s36 offen offset:3072 nt lds
    s_waitcnt vmcnt(21)
    s_add_u32 m0, m0, 0x1000
    s_add_u32 s36, s36, 0x1000
    s_and_b32 s36, s36, 0xffff
    buffer_load_dwordx4 v4, s[32:35], s36 offen nt lds
    s_waitcnt vmcnt(21)
    buffer_load_dwordx4 v4, s[32:35], s36 offen offset:1024 nt lds
    s_waitcnt vmcnt(21)
    buffer_load_dwordx4 v4, s[32:35], s36 offen offset:2048 nt lds
    s_waitcnt vmcnt(21)
    buffer_load_dwordx4 v4, s[32:35], s36 offen offset:3072 nt lds
    s_waitcnt vmcnt(21)
    s_add_u32 m0, m0, 0x1000
    s_add_u32 s36, s36, 0x1000
    s_and_b32 s36, s36, 0xffff
    buffer_load_dwordx4 v4, s[32:35], s36 offen nt lds
    s_waitcnt vmcnt(21)
    v_mov_b32 v17, 7
    s_mov_b64 exec, 1
    ds_write_b32 v16, v17 offset:0
    s_mov_b64 exec, -1
    buffer_load_dwordx4 v4, s[32:35], s36 offen offset:1024 nt lds
    s_waitcnt vmcnt(21)
    buffer_load_dwordx4 v4, s[32:35], s36 offen offset:2048 nt lds
    s_waitcnt vmcnt(21)
    buffer_load_dwordx4 v4, s[32:35], s36 offen offset:3072 nt lds
    s_waitcnt vmcnt(21)
    s_add_u32 m0, m0, 0x1000
    s_add_u32 s36, s36, 0x1000
    s_and_b32 s36, s36, 0xffff
    buffer_load_dwordx4 v4, s[32:35], s36 offen nt lds
    s_waitcnt vmcnt(21)
    buffer_load_dwordx4 v4, s[32:35], s36 offen offset:1024 nt lds
    s_waitcnt vmcnt(21)
    buffer_load_dwordx4 v4, s[32:35], s36 offen offset:2048 nt lds
    s_waitcnt vmcnt(21)
    buffer_load_dwordx4 v4, s[32:35], s36 offen offset:3072 nt lds
    s_waitcnt vmcnt(21)
    s_add_u32 m0, m0, 0x1000
    s_add_u32 s36, s36, 0x1000
    s_and_b32 s36, s36, 0xffff
    buffer_load_dwordx4 v4, s[32:35], s36 offen nt lds
    s_waitcnt vmcnt(21)
    buffer_load_dwordx4 v4, s[32:35], s36 offen offset:1024 nt lds
    s_waitcnt vmcnt(21)
    buffer_load_dwordx4 v4, s[32:35], s36 offen offset:2048 nt lds
    s_waitcnt vmcnt(21)
    buffer_load_dwordx4 v4, s[32:35], s36 offen offset:3072 nt lds
    s_waitcnt vmcnt(21)
    s_mov_b32 s44, 0
LW_1:
    ds_read_b32 v19, v16 offset:4
    s_add_u32 s44, s44, 1
    s_cmp_gt_u32 s44, 262144
    s_cbranch_scc1 LX_2
    s_waitcnt lgkmcnt(0)
    v_readfirstlane_b32 s43, v19
    s_cmp_lt_u32 s43, 4
    s_cbranch_scc1 LW_1
LX_2:
    s_waitcnt lgkmcnt(0)
    s_cmp_ge_u32 s29, 9
    s_cbranch_scc1 L_ld_o
    v_lshrrev_b32 v20, 2, v1
    v_mul_u32_u24 v20, 9216, v20
    v_and_b32 v21, 3, v1
    v_lshlrev_b32 v21, 4, v21
    v_add_u32 v10, v20, v21
    s_mul_i32 s45, s28, 288
    s_lshl_b32 s46, s29, 5
    s_add_u32 s45, s45, s46
    s_add_u32 s47, s28, s29
    s_and_b32 s47, s47, 1
    s_mul_i32 s47, s47, 18
    s_lshl_b32 s40, s45, 1
    s_add_u32 s40, s40, s16
    s_lshr_b32 s40, s40, 7
    s_and_b32 s40, s40, 7
    s_cmp_eq_u32 s40, 3
    s_cselect_b32 s49, 2, 1
    s_mov_b32 s49, 1
    v_mov_b32 v17, s49
    s_mov_b64 exec, 1
    ds_write_b32 v16, v17 offset:40
    s_mov_b64 exec, -1
    s_mul_i32 s40, s45, 1152
    s_add_u32 s32, s20, s40
    s_addc_u32 s33, s21, 0
    s_mov_b32 s34, 36864
    s_mov_b32 m0, 0
    s_mov_b32 s36, 0
    s_nop 0
    buffer_load_dwordx4 v4, s[32:35], s36 offen nt lds
    s_waitcnt vmcnt(19)
    buffer_load_dwordx4 v4, s[32:35], s36 offen offset:1024 nt lds
    s_waitcnt vmcnt(19)
    buffer_load_dwordx4 v4, s[32:35], s36 offen offset:2048 nt lds
    s_waitcnt vmcnt(19)
    v_mov_b32 v17, 8
    s_mov_b64 exec, 1
    ds_write_b32 v16, v17 offset:0
    s_mov_b64 exec, -1
    buffer_load_dwordx4 v4, s[32:35], s36 offen offset:3072 nt lds
    s_waitcnt vmcnt(19)
    s_add_u32 m0, m0, 0x1000
    s_add_u32 s36, s36, 0x1000
    buffer_load_dwordx4 v4, s[32:35], s36 offen nt lds
    s_waitcnt vmcnt(19)
    buffer_load_dwordx4 v4, s[32:35], s36 offen offset:1024 nt lds
    s_waitcnt vmcnt(19)
    buffer_load_dwordx4 v4, s[32:35], s36 offen offset:2048 nt lds
    s_waitcnt vmcnt(19)
    buffer_load_dwordx4 v4, s[32:35], s36 offen offset:3072 nt lds
    s_waitcnt vmcnt(19)
    s_add_u32 m0, m0, 0x1000
    s_add_u32 s36, s36, 0x1000
    buffer_load_dwordx4 v4, s[32:35], s36 offen nt lds
    s_waitcnt vmcnt(19)
    buffer_load_dwordx4 v4, s[32:35], s36 offen offset:1024 nt lds
    s_waitcnt vmcnt(19)
    buffer_load_dwordx4 v4, s[32:35], s36 offen offset:2048 nt lds
    s_waitcnt vmcnt(19)
    buffer_load_dwordx4 v4, s[32:35], s36 offen offset:3072 nt lds
    s_waitcnt vmcnt(19)
    s_add_u32 m0, m0, 0x1000
    s_add_u32 s36, s36, 0x1000
    buffer_load_dwordx4 v4, s[32:35], s36 offen nt lds
    s_waitcnt vmcnt(19)
    buffer_load_dwordx4 v4, s[32:35], s36 offen offset:1024 nt lds
    s_waitcnt vmcnt(19)
    buffer_load_dwordx4 v4, s[32:35], s36 offen offset:2048 nt lds
    s_waitcnt vmcnt(19)
    buffer_load_dwordx4 v4, s[32:35], s36 offen offset:3072 nt lds
    s_waitcnt vmcnt(19)
    s_add_u32 m0, m0, 0x1000
    s_add_u32 s36, s36, 0x1000
    buffer_load_dwordx4 v4, s[32:35], s36 offen nt lds
    s_waitcnt vmcnt(19)
    buffer_load_dwordx4 v4, s[32:35], s36 offen offset:1024 nt lds
    s_waitcnt vmcnt(19)
    buffer_load_dwordx4 v4, s[32:35], s36 offen offset:2048 nt lds
    s_waitcnt vmcnt(19)
    v_mov_b32 v17, 9
    s_mov_b64 exec, 1
    ds_write_b32 v16, v17 offset:0
    s_mov_b64 exec, -1
    buffer_load_dwordx4 v4, s[32:35], s36 offen offset:3072 nt lds
    s_waitcnt vmcnt(19)
    s_add_u32 m0, m0, 0x1000
    s_add_u32 s36, s36, 0x1000
    buffer_load_dwordx4 v4, s[32:35], s36 offen nt lds
    s_waitcnt vmcnt(19)
    buffer_load_dwordx4 v4, s[32:35], s36 offen offset:1024 nt lds
    s_waitcnt vmcnt(19)
    buffer_load_dwordx4 v4, s[32:35], s36 offen offset:2048 nt lds
    s_waitcnt vmcnt(19)
    buffer_load_dwordx4 v4, s[32:35], s36 offen offset:3072 nt lds
    s_waitcnt vmcnt(19)
    s_add_u32 m0, m0, 0x1000
    s_add_u32 s36, s36, 0x1000
    buffer_load_dwordx4 v4, s[32:35], s36 offen nt lds
    s_waitcnt vmcnt(19)
    buffer_load_dwordx4 v4, s[32:35], s36 offen offset:1024 nt lds
    s_waitcnt vmcnt(19)
    buffer_load_dwordx4 v4, s[32:35], s36 offen offset:2048 nt lds
    s_waitcnt vmcnt(19)
    buffer_load_dwordx4 v4, s[32:35], s36 offen offset:3072 nt lds
    s_waitcnt vmcnt(19)
    s_add_u32 m0, m0, 0x1000
    s_add_u32 s36, s36, 0x1000
    buffer_load_dwordx4 v4, s[32:35], s36 offen nt lds
    s_waitcnt vmcnt(19)
    buffer_load_dwordx4 v4, s[32:35], s36 offen offset:1024 nt lds
    s_waitcnt vmcnt(19)
    buffer_load_dwordx4 v4, s[32:35], s36 offen offset:2048 nt lds
    s_waitcnt vmcnt(19)
    buffer_load_dwordx4 v4, s[32:35], s36 offen offset:3072 nt lds
    s_waitcnt vmcnt(19)
    s_add_u32 m0, m0, 0x1000
    s_add_u32 s36, s36, 0x1000
    buffer_load_dwordx4 v4, s[32:35], s36 offen nt lds
    s_waitcnt vmcnt(19)
    buffer_load_dwordx4 v4, s[32:35], s36 offen offset:1024 nt lds
    s_waitcnt vmcnt(19)
    buffer_load_dwordx4 v4, s[32:35], s36 offen offset:2048 nt lds
    s_waitcnt vmcnt(19)
    buffer_load_dwordx4 v4, s[32:35], s36 offen offset:3072 nt lds
    s_waitcnt vmcnt(19)
    s_lshl_b32 s40, s45, 1
    s_add_u32 s32, s16, s40
    s_addc_u32 s33, s17, 0
    s_sub_u32 s34, 5308416, s40
    s_mov_b32 m0, 36864
    s_mov_b32 s36, 0
    s_lshl_b32 s48, s47, 10
    s_add_u32 m0, s48, 36864
    s_mul_i32 s36, s47, 147456
    s_nop 0
    buffer_load_dwordx4 v10, s[32:35], s36 offen  lds
    s_waitcnt vmcnt(15)
    s_add_u32 m0, m0, 0x400
    s_add_u32 s36, s36, 147456
    buffer_load_dwordx4 v10, s[32:35], s36 offen  lds
    s_waitcnt vmcnt(15)
    s_add_u32 m0, m0, 0x400
    s_add_u32 s36, s36, 147456
    buffer_load_dwordx4 v10, s[32:35], s36 offen  lds
    s_waitcnt vmcnt(15)
    s_add_u32 m0, m0, 0x400
    s_add_u32 s36, s36, 147456
    buffer_load_dwordx4 v10, s[32:35], s36 offen  lds
    s_waitcnt vmcnt(15)
    s_add_u32 m0, m0, 0x400
    s_add_u32 s36, s36, 147456
    buffer_load_dwordx4 v10, s[32:35], s36 offen  lds
    s_waitcnt vmcnt(15)
    s_add_u32 m0, m0, 0x400
    s_add_u32 s36, s36, 147456
    buffer_load_dwordx4 v10, s[32:35], s36 offen  lds
    s_waitcnt vmcnt(15)
    s_add_u32 m0, m0, 0x400
    s_add_u32 s36, s36, 147456
    buffer_load_dwordx4 v10, s[32:35], s36 offen  lds
    s_waitcnt vmcnt(15)
    s_add_u32 m0, m0, 0x400
    s_add_u32 s36, s36, 147456
    buffer_load_dwordx4 v10, s[32:35], s36 offen  lds
    s_waitcnt vmcnt(15)
    s_add_u32 m0, m0, 0x400
    s_add_u32 s36, s36, 147456
    buffer_load_dwordx4 v10, s[32:35], s36 offen  lds
    s_waitcnt vmcnt(15)
    s_add_u32 m0, m0, 0x400
    s_add_u32 s36, s36, 147456
    buffer_load_dwordx4 v10, s[32:35], s36 offen  lds
    s_waitcnt vmcnt(15)
    s_add_u32 m0, m0, 0x400
    s_add_u32 s36, s36, 147456
    buffer_load_dwordx4 v10, s[32:35], s36 offen  lds
    s_waitcnt vmcnt(15)
    s_add_u32 m0, m0, 0x400
    s_add_u32 s36, s36, 147456
    buffer_load_dwordx4 v10, s[32:35], s36 offen  lds
    s_waitcnt vmcnt(15)
    s_add_u32 m0, m0, 0x400
    s_add_u32 s36, s36, 147456
    buffer_load_dwordx4 v10, s[32:35], s36 offen  lds
    s_waitcnt vmcnt(15)
    s_add_u32 m0, m0, 0x400
    s_add_u32 s36, s36, 147456
    buffer_load_dwordx4 v10, s[32:35], s36 offen  lds
    s_waitcnt vmcnt(15)
    s_add_u32 m0, m0, 0x400
    s_add_u32 s36, s36, 147456
    buffer_load_dwordx4 v10, s[32:35], s36 offen  lds
    s_waitcnt vmcnt(15)
    v_mov_b32 v17, 10
    s_mov_b64 exec, 1
    ds_write_b32 v16, v17 offset:0
    s_mov_b64 exec, -1
    s_add_u32 m0, m0, 0x400
    s_add_u32 s36, s36, 147456
    buffer_load_dwordx4 v10, s[32:35], s36 offen  lds
    s_waitcnt vmcnt(15)
    s_add_u32 m0, m0, 0x400
    s_add_u32 s36, s36, 147456
    buffer_load_dwordx4 v10, s[32:35], s36 offen  lds
    s_waitcnt vmcnt(15)
    s_add_u32 m0, m0, 0x400
    s_add_u32 s36, s36, 147456
    buffer_load_dwordx4 v10, s[32:35], s36 offen  lds
    s_waitcnt vmcnt(15)
    s_cmp_lg_u32 s47, 0
    s_cselect_b32 s48, 36864, 0
    s_cselect_b32 s52, 5308416, 0
    s_sub_u32 m0, m0, s48
    s_sub_u32 s36, s36, s52
    s_add_u32 m0, m0, 0x400
    s_add_u32 s36, s36, 147456
    buffer_load_dwordx4 v10, s[32:35], s36 offen  lds
    s_waitcnt vmcnt(15)
    s_add_u32 m0, m0, 0x400
    s_add_u32 s36, s36, 147456
    buffer_load_dwordx4 v10, s[32:35], s36 offen  lds
    s_waitcnt vmcnt(15)
    s_add_u32 m0, m0, 0x400
    s_add_u32 s36, s36, 147456
    buffer_load_dwordx4 v10, s[32:35], s36 offen  lds
    s_waitcnt vmcnt(15)
    s_add_u32 m0, m0, 0x400
    s_add_u32 s36, s36, 147456
    buffer_load_dwordx4 v10, s[32:35], s36 offen  lds
    s_waitcnt vmcnt(15)
    s_add_u32 m0, m0, 0x400
    s_add_u32 s36, s36, 147456
    buffer_load_dwordx4 v10, s[32:35], s36 offen  lds
    s_waitcnt vmcnt(15)
    s_add_u32 m0, m0, 0x400
    s_add_u32 s36, s36, 147456
    buffer_load_dwordx4 v10, s[32:35], s36 offen  lds
    s_waitcnt vmcnt(15)
    s_add_u32 m0, m0, 0x400
    s_add_u32 s36, s36, 147456
    buffer_load_dwordx4 v10, s[32:35], s36 offen  lds
    s_waitcnt vmcnt(15)
    s_add_u32 m0, m0, 0x400
    s_add_u32 s36, s36, 147456
    buffer_load_dwordx4 v10, s[32:35], s36 offen  lds
    s_waitcnt vmcnt(15)
    s_add_u32 m0, m0, 0x400
    s_add_u32 s36, s36, 147456
    buffer_load_dwordx4 v10, s[32:35], s36 offen  lds
    s_waitcnt vmcnt(15)
    s_add_u32 m0, m0, 0x400
    s_add_u32 s36, s36, 147456
    buffer_load_dwordx4 v10, s[32:35], s36 offen  lds
    s_waitcnt vmcnt(15)
    s_add_u32 m0, m0, 0x400
    s_add_u32 s36, s36, 147456
    buffer_load_dwordx4 v10, s[32:35], s36 offen  lds
    s_waitcnt vmcnt(15)
    s_add_u32 m0, m0, 0x400
    s_add_u32 s36, s36, 147456
    buffer_load_dwordx4 v10, s[32:35], s36 offen  lds
    s_waitcnt vmcnt(15)
    s_add_u32 m0, m0, 0x400
    s_add_u32 s36, s36, 147456
    buffer_load_dwordx4 v10, s[32:35], s36 offen  lds
    s_waitcnt vmcnt(15)
    s_add_u32 m0, m0, 0x400
    s_add_u32 s36, s36, 147456
    buffer_load_dwordx4 v10, s[32:35], s36 offen  lds
    s_waitcnt vmcnt(15)
    s_add_u32 m0, m0, 0x400
    s_add_u32 s36, s36, 147456
    buffer_load_dwordx4 v10, s[32:35], s36 offen  lds
    s_waitcnt vmcnt(15)
    s_add_u32 m0, m0, 0x400
    s_add_u32 s36, s36, 147456
    buffer_load_dwordx4 v10, s[32:35], s36 offen  lds
    s_waitcnt vmcnt(15)
    s_add_u32 m0, m0, 0x400
    s_add_u32 s36, s36, 147456
    buffer_load_dwordx4 v10, s[32:35], s36 offen  lds
    s_waitcnt vmcnt(15)
    s_add_u32 m0, m0, 0x400
    s_add_u32 s36, s36, 147456
    buffer_load_dwordx4 v10, s[32:35], s36 offen  lds
    s_waitcnt vmcnt(15)
    s_mov_b32 s44, 0
LW_3:
    ds_read_b32 v19, v16 offset:8
    s_add_u32 s44, s44, 1
    s_cmp_gt_u32 s44, 262144
    s_cbranch_scc1 LX_4
    s_waitcnt lgkmcnt(0)
    v_readfirstlane_b32 s43, v19
    s_cmp_lt_u32 s43, 4
    s_cbranch_scc1 LW_3
LX_4:
    s_waitcnt lgkmcnt(0)
    s_lshl_b32 s40, s45, 1
    s_add_u32 s32, s18, s40
    s_addc_u32 s33, s19, 0
    s_sub_u32 s34, 5308416, s40
    s_mov_b32 m0, 83968
    s_mov_b32 s36, 0
    s_lshl_b32 s48, s47, 10
    s_add_u32 m0, s48, 83968
    s_mul_i32 s36, s47, 147456
    s_nop 0
    buffer_load_dwordx4 v10, s[32:35], s36 offen  lds
    s_waitcnt vmcnt(15)
    s_add_u32 m0, m0, 0x400
    s_add_u32 s36, s36, 147456
    buffer_load_dwordx4 v10, s[32:35], s36 offen  lds
    s_waitcnt vmcnt(15)
    s_add_u32 m0, m0, 0x400
    s_add_u32 s36, s36, 147456
    buffer_load_dwordx4 v10, s[32:35], s36 offen  lds
    s_waitcnt vmcnt(15)
    s_add_u32 m0, m0, 0x400
    s_add_u32 s36, s36, 147456
    buffer_load_dwordx4 v10, s[32:35], s36 offen  lds
    s_waitcnt vmcnt(15)
    s_add_u32 m0, m0, 0x400
    s_add_u32 s36, s36, 147456
    buffer_load_dwordx4 v10, s[32:35], s36 offen  lds
    s_waitcnt vmcnt(15)
    s_add_u32 m0, m0, 0x400
    s_add_u32 s36, s36, 147456
    buffer_load_dwordx4 v10, s[32:35], s36 offen  lds
    s_waitcnt vmcnt(15)
    s_add_u32 m0, m0, 0x400
    s_add_u32 s36, s36, 147456
    buffer_load_dwordx4 v10, s[32:35], s36 offen  lds
    s_waitcnt vmcnt(15)
    s_add_u32 m0, m0, 0x400
    s_add_u32 s36, s36, 147456
    buffer_load_dwordx4 v10, s[32:35], s36 offen  lds
    s_waitcnt vmcnt(15)
    s_add_u32 m0, m0, 0x400
    s_add_u32 s36, s36, 147456
    buffer_load_dwordx4 v10, s[32:35], s36 offen  lds
    s_waitcnt vmcnt(15)
    s_add_u32 m0, m0, 0x400
    s_add_u32 s36, s36, 147456
    buffer_load_dwordx4 v10, s[32:35], s36 offen  lds
    s_waitcnt vmcnt(15)
    s_add_u32 m0, m0, 0x400
    s_add_u32 s36, s36, 147456
    buffer_load_dwordx4 v10, s[32:35], s36 offen  lds
    s_waitcnt vmcnt(15)
    s_add_u32 m0, m0, 0x400
    s_add_u32 s36, s36, 147456
    buffer_load_dwordx4 v10, s[32:35], s36 offen  lds
    s_waitcnt vmcnt(15)
    s_add_u32 m0, m0, 0x400
    s_add_u32 s36, s36, 147456
    buffer_load_dwordx4 v10, s[32:35], s36 offen  lds
    s_waitcnt vmcnt(15)
    s_add_u32 m0, m0, 0x400
    s_add_u32 s36, s36, 147456
    buffer_load_dwordx4 v10, s[32:35], s36 offen  lds
    s_waitcnt vmcnt(15)
    s_add_u32 m0, m0, 0x400
    s_add_u32 s36, s36, 147456
    buffer_load_dwordx4 v10, s[32:35], s36 offen  lds
    s_waitcnt vmcnt(15)
    v_mov_b32 v17, 11
    s_mov_b64 exec, 1
    ds_write_b32 v16, v17 offset:0
    s_mov_b64 exec, -1
    s_add_u32 m0, m0, 0x400
    s_add_u32 s36, s36, 147456
    buffer_load_dwordx4 v10, s[32:35], s36 offen  lds
    s_waitcnt vmcnt(15)
    s_add_u32 m0, m0, 0x400
    s_add_u32 s36, s36, 147456
    buffer_load_dwordx4 v10, s[32:35], s36 offen  lds
    s_waitcnt vmcnt(15)
    s_add_u32 m0, m0, 0x400
    s_add_u32 s36, s36, 147456
    buffer_load_dwordx4 v10, s[32:35], s36 offen  lds
    s_waitcnt vmcnt(15)
    s_cmp_lg_u32 s47, 0
    s_cselect_b32 s48, 36864, 0
    s_cselect_b32 s52, 5308416, 0
    s_sub_u32 m0, m0, s48
    s_sub_u32 s36, s36, s52
    s_add_u32 m0, m0, 0x400
    s_add_u32 s36, s36, 147456
    buffer_load_dwordx4 v10, s[32:35], s36 offen  lds
    s_waitcnt vmcnt(15)
    s_add_u32 m0, m0, 0x400
    s_add_u32 s36, s36, 147456
    buffer_load_dwordx4 v10, s[32:35], s36 offen  lds
    s_waitcnt vmcnt(15)
    s_add_u32 m0, m0, 0x400
    s_add_u32 s36, s36, 147456
    buffer_load_dwordx4 v10, s[32:35], s36 offen  lds
    s_waitcnt vmcnt(15)
    s_add_u32 m0, m0, 0x400
    s_add_u32 s36, s36, 147456
    buffer_load_dwordx4 v10, s[32:35], s36 offen  lds
    s_waitcnt vmcnt(15)
    s_add_u32 m0, m0, 0x400
    s_add_u32 s36, s36, 147456
    buffer_load_dwordx4 v10, s[32:35], s36 offen  lds
    s_waitcnt vmcnt(15)
    s_add_u32 m0, m0, 0x400
    s_add_u32 s36, s36, 147456
    buffer_load_dwordx4 v10, s[32:35], s36 offen  lds
    s_waitcnt vmcnt(15)
    s_add_u32 m0, m0, 0x400
    s_add_u32 s36, s36, 147456
    buffer_load_dwordx4 v10, s[32:35], s36 offen  lds
    s_waitcnt vmcnt(15)
    s_add_u32 m0, m0, 0x400
    s_add_u32 s36, s36, 147456
    buffer_load_dwordx4 v10, s[32:35], s36 offen  lds
    s_waitcnt vmcnt(15)
    s_add_u32 m0, m0, 0x400
    s_add_u32 s36, s36, 147456
    buffer_load_dwordx4 v10, s[32:35], s36 offen  lds
    s_waitcnt vmcnt(15)
    s_add_u32 m0, m0, 0x400
    s_add_u32 s36, s36, 147456
    buffer_load_dwordx4 v10, s[32:35], s36 offen  lds
    s_waitcnt vmcnt(15)
    s_add_u32 m0, m0, 0x400
    s_add_u32 s36, s36, 147456
    buffer_load_dwordx4 v10, s[32:35], s36 offen  lds
    s_waitcnt vmcnt(15)
    s_add_u32 m0, m0, 0x400
    s_add_u32 s36, s36, 147456
    buffer_load_dwordx4 v10, s[32:35], s36 offen  lds
    s_waitcnt vmcnt(15)
    s_add_u32 m0, m0, 0x400
    s_add_u32 s36, s36, 147456
    buffer_load_dwordx4 v10, s[32:35], s36 offen  lds
    s_waitcnt vmcnt(15)
    s_add_u32 m0, m0, 0x400
    s_add_u32 s36, s36, 147456
    buffer_load_dwordx4 v10, s[32:35], s36 offen  lds
    s_waitcnt vmcnt(15)
    s_add_u32 m0, m0, 0x400
    s_add_u32 s36, s36, 147456
    buffer_load_dwordx4 v10, s[32:35], s36 offen  lds
    s_waitcnt vmcnt(15)
    s_add_u32 m0, m0, 0x400
    s_add_u32 s36, s36, 147456
    buffer_load_dwordx4 v10, s[32:35], s36 offen  lds
    s_waitcnt vmcnt(15)
    s_add_u32 m0, m0, 0x400
    s_add_u32 s36, s36, 147456
    buffer_load_dwordx4 v10, s[32:35], s36 offen  lds
    s_waitcnt vmcnt(15)
    s_add_u32 m0, m0, 0x400
    s_add_u32 s36, s36, 147456
    buffer_load_dwordx4 v10, s[32:35], s36 offen  lds
    s_waitcnt vmcnt(15)
    v_mov_b32 v17, 1
    s_mov_b64 exec, 1
    ds_write_b32 v16, v17 offset:12
    s_mov_b64 exec, -1
    s_waitcnt vmcnt(0)
    v_mov_b32 v17, 12
    s_mov_b64 exec, 1
    ds_write_b32 v16, v17 offset:0
    s_mov_b64 exec, -1
    s_branch L_ld_done
L_ld_o:
    s_cmp_eq_u32 s29, 15
    s_cbranch_scc1 L_ld_spare
    s_sub_u32 s41, s29, 9
    s_lshl_b32 s40, s28, 7
    s_lshl_b32 s44, s41, 2
    s_add_u32 s40, s40, s44
    s_add_u32 s40, s40, 249856
    s_add_u32 s58, s58, 1
    v_lshlrev_b32 v20, 2, v1
    v_add_u32 v20, s40, v20
    v_mov_b32 v21, s58
    s_mov_b64 exec, 1
    s_cmp_eq_u32 s41, 5
    s_cselect_b32 exec_lo, 7, exec_lo
    global_store_dword v20, v21, s[26:27] sc1
    s_mov_b64 exec, -1
    v_add_u32 v20, 0, v1
    v_mul_u32_u24 v21, 171, v20
    v_lshrrev_b32 v21, 11, v21
    v_mul_u32_u24 v22, 12, v21
    v_sub_u32 v22, v20, v22
    v_lshlrev_b32 v22, 4, v22
    v_mul_u32_u24 v21, 1152, v21
    v_add_u32 v10, v21, v22
    v_add_u32 v20, 64, v1
    v_mul_u32_u24 v21, 171, v20
    v_lshrrev_b32 v21, 11, v21
    v_mul_u32_u24 v22, 12, v21
    v_sub_u32 v22, v20, v22
    v_lshlrev_b32 v22, 4, v22
    v_mul_u32_u24 v21, 1152, v21
    v_add_u32 v11, v21, v22
    v_add_u32 v20, 128, v1
    v_mul_u32_u24 v21, 171, v20
    v_lshrrev_b32 v21, 11, v21
    v_mul_u32_u24 v22, 12, v21
    v_sub_u32 v22, v20, v22
    v_lshlrev_b32 v22, 4, v22
    v_mul_u32_u24 v21, 1152, v21
    v_add_u32 v12, v21, v22
    s_mul_i32 s40, s28, 294912
    s_sub_u32 s41, s29, 9
    s_mul_i32 s41, s41, 192
    s_add_u32 s40, s40, s41
    s_add_u32 s32, s12, s40
    s_addc_u32 s33, s13, 0
    s_sub_u32 s34, 4718592, s40
    s_mov_b32 m0, 0
    s_mov_b32 s36, 0
    s_and_b32 s47, s29, 1
    s_mul_i32 s48, s47, 24576
    s_add_u32 m0, s48, 0
    s_mul_i32 s36, s47, 147456
    s_nop 0
    buffer_load_dwordx4 v10, s[32:35], s36 offen  lds
    s_waitcnt vmcnt(21)
    s_add_u32 m0, m0, 0x400
    s_nop 0
    buffer_load_dwordx4 v11, s[32:35], s36 offen  lds
    s_waitcnt vmcnt(21)
    s_add_u32 m0, m0, 0x400
    s_nop 0
    buffer_load_dwordx4 v12, s[32:35], s36 offen  lds
    s_waitcnt vmcnt(21)
    s_add_u32 m0, m0, 0x400
    s_add_u32 s36, s36, 18432
    buffer_load_dwordx4 v10, s[32:35], s36 offen  lds
    s_waitcnt vmcnt(21)
    v_mov_b32 v17, 8
    s_mov_b64 exec, 1
    ds_write_b32 v16, v17 offset:0
    s_mov_b64 exec, -1
    s_add_u32 m0, m0, 0x400
    s_nop 0
    buffer_load_dwordx4 v11, s[32:35], s36 offen  lds
    s_waitcnt vmcnt(21)
    s_add_u32 m0, m0, 0x400
    s_nop 0
    buffer_load_dwordx4 v12, s[32:35], s36 offen  lds
    s_waitcnt vmcnt(21)
    s_add_u32 m0, m0, 0x400
    s_add_u32 s36, s36, 18432
    buffer_load_dwordx4 v10, s[32:35], s36 offen  lds
    s_waitcnt vmcnt(21)
    s_add_u32 m0, m0, 0x400
    s_nop 0
    buffer_load_dwordx4 v11, s[32:35], s36 offen  lds
    s_waitcnt vmcnt(21)
    s_add_u32 m0, m0, 0x400
    s_nop 0
    buffer_load_dwordx4 v12, s[32:35], s36 offen  lds
    s_waitcnt vmcnt(21)
    s_add_u32 m0, m0, 0x400
    s_add_u32 s36, s36, 18432
    buffer_load_dwordx4 v10, s[32:35], s36 offen  lds
    s_waitcnt vmcnt(21)
    s_add_u32 m0, m0, 0x400
    s_nop 0
    buffer_load_dwordx4 v11, s[32:35], s36 offen  lds
    s_waitcnt vmcnt(21)
    s_add_u32 m0, m0, 0x400
    s_nop 0
    buffer_load_dwordx4 v12, s[32:35], s36 offen  lds
    s_waitcnt vmcnt(21)
    s_add_u32 m0, m0, 0x400
    s_add_u32 s36, s36, 18432
    buffer_load_dwordx4 v10, s[32:35], s36 offen  lds
    s_waitcnt vmcnt(21)
    s_add_u32 m0, m0, 0x400
    s_nop 0
    buffer_load_dwordx4 v11, s[32:35], s36 offen  lds
    s_waitcnt vmcnt(21)
    s_add_u32 m0, m0, 0x400
    s_nop 0
    buffer_load_dwordx4 v12, s[32:35], s36 offen  lds
    s_waitcnt vmcnt(21)
    s_add_u32 m0, m0, 0x400
    s_add_u32 s36, s36, 18432
    buffer_load_dwordx4 v10, s[32:35], s36 offen  lds
    s_waitcnt vmcnt(21)
    s_add_u32 m0, m0, 0x400
    s_nop 0
    buffer_load_dwordx4 v11, s[32:35], s36 offen  lds
    s_waitcnt vmcnt(21)
    s_add_u32 m0, m0, 0x400
    s_nop 0
    buffer_load_dwordx4 v12, s[32:35], s36 offen  lds
    s_waitcnt vmcnt(21)
    s_add_u32 m0, m0, 0x400
    s_add_u32 s36, s36, 18432
    buffer_load_dwordx4 v10, s[32:35], s36 offen  lds
    s_waitcnt vmcnt(21)
    s_add_u32 m0, m0, 0x400
    s_nop 0
    buffer_load_dwordx4 v11, s[32:35], s36 offen  lds
    s_waitcnt vmcnt(21)
    v_mov_b32 v17, 9
    s_mov_b64 exec, 1
    ds_write_b32 v16, v17 offset:0
    s_mov_b64 exec, -1
    s_add_u32 m0, m0, 0x400
    s_nop 0
    buffer_load_dwordx4 v12, s[32:35], s36 offen  lds
    s_waitcnt vmcnt(21)
    s_add_u32 m0, m0, 0x400
    s_add_u32 s36, s36, 18432
    buffer_load_dwordx4 v10, s[32:35], s36 offen  lds
    s_waitcnt vmcnt(21)
    s_add_u32 m0, m0, 0x400
    s_nop 0
    buffer_load_dwordx4 v11, s[32:35], s36 offen  lds
    s_waitcnt vmcnt(21)
    s_add_u32 m0, m0, 0x400
    s_nop 0
    buffer_load_dwordx4 v12, s[32:35], s36 offen  lds
    s_waitcnt vmcnt(21)
    s_cmp_lg_u32 s47, 0
    s_cselect_b32 s48, 49152, 0
    s_cselect_b32 s49, 294912, 0
    s_sub_u32 m0, m0, s48
    s_sub_u32 s36, s36, s49
    s_add_u32 m0, m0, 0x400
    s_add_u32 s36, s36, 18432
    buffer_load_dwordx4 v10, s[32:35], s36 offen  lds
    s_waitcnt vmcnt(21)
    s_add_u32 m0, m0, 0x400
    s_nop 0
    buffer_load_dwordx4 v11, s[32:35], s36 offen  lds
    s_waitcnt vmcnt(21)
    s_add_u32 m0, m0, 0x400
    s_nop 0
    buffer_load_dwordx4 v12, s[32:35], s36 offen  lds
    s_waitcnt vmcnt(21)
    s_add_u32 m0, m0, 0x400
    s_add_u32 s36, s36, 18432
    buffer_load_dwordx4 v10, s[32:35], s36 offen  lds
    s_waitcnt vmcnt(21)
    s_add_u32 m0, m0, 0x400
    s_nop 0
    buffer_load_dwordx4 v11, s[32:35], s36 offen  lds
    s_waitcnt vmcnt(21)
    s_add_u32 m0, m0, 0x400
    s_nop 0
    buffer_load_dwordx4 v12, s[32:35], s36 offen  lds
    s_waitcnt vmcnt(21)
    s_add_u32 m0, m0, 0x400
    s_add_u32 s36, s36, 18432
    buffer_load_dwordx4 v10, s[32:35], s36 offen  lds
    s_waitcnt vmcnt(21)
    s_add_u32 m0, m0, 0x400
    s_nop 0
    buffer_load_dwordx4 v11, s[32:35], s36 offen  lds
    s_waitcnt vmcnt(21)
    s_add_u32 m0, m0, 0x400
    s_nop 0
    buffer_load_dwordx4 v12, s[32:35], s36 offen  lds
    s_waitcnt vmcnt(21)
    v_mov_b32 v17, 10
    s_mov_b64 exec, 1
    ds_write_b32 v16, v17 offset:0
    s_mov_b64 exec, -1
    s_add_u32 m0, m0, 0x400
    s_add_u32 s36, s36, 18432
    buffer_load_dwordx4 v10, s[32:35], s36 offen  lds
    s_waitcnt vmcnt(21)
    s_add_u32 m0, m0, 0x400
    s_nop 0
    buffer_load_dwordx4 v11, s[32:35], s36 offen  lds
    s_waitcnt vmcnt(21)
    s_add_u32 m0, m0, 0x400
    s_nop 0
    buffer_load_dwordx4 v12, s[32:35], s36 offen  lds
    s_waitcnt vmcnt(21)
    s_add_u32 m0, m0, 0x400
    s_add_u32 s36, s36, 18432
    buffer_load_dwordx4 v10, s[32:35], s36 offen  lds
    s_waitcnt vmcnt(21)
    s_add_u32 m0, m0, 0x400
    s_nop 0
    buffer_load_dwordx4 v11, s[32:35], s36 offen  lds
    s_waitcnt vmcnt(21)
    s_add_u32 m0, m0, 0x400
    s_nop 0
    buffer_load_dwordx4 v12, s[32:35], s36 offen  lds
    s_waitcnt vmcnt(21)
    s_add_u32 m0, m0, 0x400
    s_add_u32 s36, s36, 18432
    buffer_load_dwordx4 v10, s[32:35], s36 offen  lds
    s_waitcnt vmcnt(21)
    s_add_u32 m0, m0, 0x400
    s_nop 0
    buffer_load_dwordx4 v11, s[32:35], s36 offen  lds
    s_waitcnt vmcnt(21)
    s_add_u32 m0, m0, 0x400
    s_nop 0
    buffer_load_dwordx4 v12, s[32:35], s36 offen  lds
    s_waitcnt vmcnt(21)
    s_add_u32 m0, m0, 0x400
    s_add_u32 s36, s36, 18432
    buffer_load_dwordx4 v10, s[32:35], s36 offen  lds
    s_waitcnt vmcnt(21)
    s_add_u32 m0, m0, 0x400
    s_nop 0
    buffer_load_dwordx4 v11, s[32:35], s36 offen  lds
    s_waitcnt vmcnt(21)
    s_add_u32 m0, m0, 0x400
    s_nop 0
    buffer_load_dwordx4 v12, s[32:35], s36 offen  lds
    s_waitcnt vmcnt(21)
    v_mov_b32 v17, 11
    s_mov_b64 exec, 1
    ds_write_b32 v16, v17 offset:0
    s_mov_b64 exec, -1
    s_add_u32 m0, m0, 0x400
    s_add_u32 s36, s36, 18432
    buffer_load_dwordx4 v10, s[32:35], s36 offen  lds
    s_waitcnt vmcnt(21)
    s_add_u32 m0, m0, 0x400
    s_nop 0
    buffer_load_dwordx4 v11, s[32:35], s36 offen  lds
    s_waitcnt vmcnt(21)
    s_add_u32 m0, m0, 0x400
    s_nop 0
    buffer_load_dwordx4 v12, s[32:35], s36 offen  lds
    s_waitcnt vmcnt(21)
    v_mov_b32 v17, 1
    s_mov_b64 exec, 1
    ds_write_b32 v16, v17 offset:12
    s_mov_b64 exec, -1
    s_waitcnt vmcnt(12)
    v_mov_b32 v17, 12
    s_mov_b64 exec, 1
    ds_write_b32 v16, v17 offset:0
    s_mov_b64 exec, -1
    s_waitcnt vmcnt(0)
    v_mov_b32 v17, 13
    s_mov_b64 exec, 1
    ds_write_b32 v16, v17 offset:0
    s_mov_b64 exec, -1
    s_branch L_ld_done
L_ld_spare:
    s_waitcnt vmcnt(16)
    v_mov_b32 v17, 8
    s_mov_b64 exec, 1
    ds_write_b32 v16, v17 offset:0
    s_mov_b64 exec, -1
    s_waitcnt vmcnt(0)
    v_mov_b32 v17, 9
    s_mov_b64 exec, 1
    ds_write_b32 v16, v17 offset:0
    s_mov_b64 exec, -1
    s_mov_b32 s44, 0
LW_5:
    ds_read_b32 v19, v16 offset:44
    s_add_u32 s44, s44, 1
    s_cmp_gt_u32 s44, 262144
    s_cbranch_scc1 LX_6
    s_waitcnt lgkmcnt(0)
    v_readfirstlane_b32 s43, v19
    s_cmp_lt_u32 s43, 1
    s_cbranch_scc1 LW_5
LX_6:
    s_waitcnt lgkmcnt(0)
    s_lshr_b32 s45, s28, 1
    s_and_b32 s46, s28, 1
    s_mul_i32 s46, s46, 288
    v_add_u32 v20, s46, v1
    s_mov_b32 s47, 9216
    v_mul_lo_u32 v20, s47, v20
    v_add_u32 v21, 589824, v20
    v_add_u32 v22, 1179648, v20
    v_add_u32 v23, 1769472, v20
    v_add_u32 v24, 2359296, v20
    s_lshr_b32 s40, s18, 7
    s_add_u32 s40, s40, s45
    s_sub_u32 s40, 3, s40
    s_and_b32 s40, s40, 7
    s_mul_i32 s41, s45, 9
    s_add_u32 s40, s40, s41
    s_lshl_b32 s40, s40, 7
    s_add_u32 s32, s18, s40
    s_addc_u32 s33, s19, 0
    s_sub_u32 s34, 5308416, s40
    s_mov_b32 s36, 0
    buffer_load_dword v32, v20, s[32:35], s36 offen
    buffer_load_dword v33, v21, s[32:35], s36 offen
    buffer_load_dword v34, v22, s[32:35], s36 offen
    buffer_load_dword v35, v23, s[32:35], s36 offen
    buffer_load_dword v36, v24, s[32:35], s36 offen
PFS_7:
    s_lshr_b32 s40, s18, 7
    s_add_u32 s40, s40, s45
    s_sub_u32 s40, 3, s40
    s_and_b32 s40, s40, 7
    s_cmp_lg_u32 s40, 0
    s_cbranch_scc1 PFS_8
    s_mov_b32 s40, 8
    s_mul_i32 s41, s45, 9
    s_add_u32 s40, s40, s41
    s_lshl_b32 s40, s40, 7
    s_add_u32 s32, s18, s40
    s_addc_u32 s33, s19, 0
    s_sub_u32 s34, 5308416, s40
    s_mov_b32 s36, 0
    buffer_load_dword v32, v20, s[32:35], s36 offen
    buffer_load_dword v33, v21, s[32:35], s36 offen
    buffer_load_dword v34, v22, s[32:35], s36 offen
    buffer_load_dword v35, v23, s[32:35], s36 offen
    buffer_load_dword v36, v24, s[32:35], s36 offen
PFS_8:
L_ld_done:
    s_endpgm
L_consumer:
    v_and_b32 v2, 15, v1
    v_lshrrev_b32 v3, 4, v1
    v_lshlrev_b32 v4, 4, v1
    v_mov_b32 v5, 158016
    s_sub_u32 s30, s3, 1
    s_load_dword s58, s[26:27], 258048
    global_load_dwordx4 v[20:23], v4, s[4:5]
    v_lshlrev_b32 v12, 2, v1
    v_mov_b32 v24, 0
    s_mov_b32 exec_hi, 0
    global_load_dword v24, v12, s[4:5] offset:1024
    s_mov_b64 exec, -1
    s_cmp_lg_u32 s30, 0
    s_cbranch_scc1 L_p0_notc0
    v_mov_b32 v28, -1
    v_mov_b32 v29, -1
    v_mov_b32 v30, -1
    v_mov_b32 v31, -1
    s_lshl_b32 s46, s28, 4
    s_add_u32 s46, s46, s29
    s_lshl_b32 s40, s46, 9
    s_add_u32 s40, s40, 98304
    s_add_u32 s42, s26, s40
    s_addc_u32 s43, s27, 0
    s_mov_b64 exec, -1
    s_mov_b32 exec_hi, 0
    global_store_dwordx4 v4, v[28:31], s[42:43]
    s_mov_b64 exec, -1
    s_cmp_ge_u32 s29, 9
    s_cbranch_scc1 L_p0_o
    v_and_b32 v12, 1, v3
    v_lshlrev_b32 v12, 3, v12
    v_lshl_add_u32 v12, v2, 4, v12
    global_load_dwordx2 v[196:197], v12, s[4:5] offset:0
    global_load_dwordx2 v[198:199], v12, s[4:5] offset:256
    global_load_dwordx2 v[200:201], v12, s[4:5] offset:512
    global_load_dwordx2 v[202:203], v12, s[4:5] offset:768
    v_mov_b32 v204, 0
    v_mov_b32 v205, 0
    s_mov_b32 exec_lo, 0xff00ff
    s_mov_b32 exec_hi, 0xff00ff
    global_load_dwordx2 v[204:205], v12, s[4:5] offset:1024
    s_mov_b64 exec, -1
    s_mov_b32 s55, 6
    s_branch L_p0_lds
L_p0_o:
    s_sub_u32 s41, s29, 9
    s_mul_i32 s40, s41, 192
    s_mul_i32 s44, s28, 1152
    s_add_u32 s40, s40, s44
    s_add_u32 s40, s40, 229376
    s_add_u32 s42, s26, s40
    s_addc_u32 s43, s27, 0
    s_mov_b32 s55, 2
    s_cmp_eq_u32 s41, 6
    s_cbranch_scc1 L_p0_lds
    s_mov_b64 exec, 0xfff
    global_store_dwordx4 v4, v[28:31], s[42:43] sc1
    s_mov_b64 exec, -1
    s_mov_b32 s55, 2
L_p0_lds:
    v_add_u32 v12, 150656, v4
    ds_write_b128 v12, v[28:31] offset:0
    ds_write_b128 v12, v[28:31] offset:1024
    ds_write_b128 v12, v[28:31] offset:2048
    ds_write_b128 v12, v[28:31] offset:3072
    ds_write_b128 v12, v[28:31] offset:4096
    ds_write_b128 v12, v[28:31] offset:5120
    ds_write_b128 v12, v[28:31] offset:6144
    v_cmp_gt_u32 vcc, 192, v4
    s_and_saveexec_b64 s[40:41], vcc
    ds_write_b128 v12, v[28:31] offset:7168
    s_mov_b64 exec, s[40:41]
    v_mov_b32 v32, 0
    v_mov_b32 v33, 0
    v_mov_b32 v34, 0
    v_mov_b32 v35, 0
    ds_write_b128 v5, v[32:35]
    ds_write_b128 v5, v[32:35] offset:16
    ds_write_b128 v5, v[32:35] offset:32
    s_waitcnt lgkmcnt(0)
    s_barrier
    s_cmp_eq_u32 s55, 2
    s_cbranch_scc1 P0W_9
    s_waitcnt vmcnt(6)
    s_branch L_p0_ln
P0W_9:
    s_waitcnt vmcnt(1)
    s_branch L_p0_ln
L_p0_notc0:
    s_barrier
    s_waitcnt vmcnt(0)
L_p0_ln:
    v_lshlrev_b32 v32, 16, v20
    v_and_b32 v33, 0xffff0000, v20
    v_lshlrev_b32 v34, 16, v21
    v_and_b32 v35, 0xffff0000, v21
    v_lshlrev_b32 v36, 16, v22
    v_and_b32 v37, 0xffff0000, v22
    v_lshlrev_b32 v38, 16, v23
    v_and_b32 v39, 0xffff0000, v23
    v_lshlrev_b32 v40, 16, v24
    v_and_b32 v41, 0xffff0000, v24
    v_add_f32 v42, v32, v33
    v_add_f32 v42, v42, v34
    v_add_f32 v42, v42, v35
    v_add_f32 v42, v42, v36
    v_add_f32 v42, v42, v37
    v_add_f32 v42, v42, v38
    v_add_f32 v42, v42, v39
    v_add_f32 v42, v42, v40
    v_add_f32 v42, v42, v41
    s_nop 1
    v_add_f32_dpp v42, v42, v42 quad_perm:[1,0,3,2] row_mask:0xf bank_mask:0xf
    s_nop 1
    v_add_f32_dpp v42, v42, v42 quad_perm:[2,3,0,1] row_mask:0xf bank_mask:0xf
    s_nop 1
    v_add_f32_dpp v42, v42, v42 row_half_mirror row_mask:0xf bank_mask:0xf
    s_nop 1
    v_add_f32_dpp v42, v42, v42 row_mirror row_mask:0xf bank_mask:0xf
    v_mov_b32 v43, v42
    s_nop 1
    v_permlane16_swap_b32 v42, v43
    s_nop 0
    v_add_f32 v42, v42, v43
    v_mov_b32 v43, v42
    s_nop 1
    v_permlane32_swap_b32 v42, v43
    s_nop 0
    v_add_f32 v42, v42, v43
    v_mul_f32 v42, 0x3ae38e39, v42
    v_sub_f32 v32, v32, v42
    v_sub_f32 v33, v33, v42
    v_sub_f32 v34, v34, v42
    v_sub_f32 v35, v35, v42
    v_sub_f32 v36, v36, v42
    v_sub_f32 v37, v37, v42
    v_sub_f32 v38, v38, v42
    v_sub_f32 v39, v39, v42
    v_sub_f32 v40, v40, v42
    v_sub_f32 v41, v41, v42
    s_mov_b32 exec_lo, 0
    v_mov_b32 v40, 0
    v_mov_b32 v41, 0
    s_mov_b64 exec, -1
    v_mul_f32 v43, v32, v32
    v_fmac_f32 v43, v33, v33
    v_fmac_f32 v43, v34, v34
    v_fmac_f32 v43, v35, v35
    v_fmac_f32 v43, v36, v36
    v_fmac_f32 v43, v37, v37
    v_fmac_f32 v43, v38, v38
    v_fmac_f32 v43, v39, v39
    v_fmac_f32 v43, v40, v40
    v_fmac_f32 v43, v41, v41
    s_nop 1
    v_add_f32_dpp v43, v43, v43 quad_perm:[1,0,3,2] row_mask:0xf bank_mask:0xf
    s_nop 1
    v_add_f32_dpp v43, v43, v43 quad_perm:[2,3,0,1] row_mask:0xf bank_mask:0xf
    s_nop 1
    v_add_f32_dpp v43, v43, v43 row_half_mirror row_mask:0xf bank_mask:0xf
    s_nop 1
    v_add_f32_dpp v43, v43, v43 row_mirror row_mask:0xf bank_mask:0xf
    v_mov_b32 v44, v43
    s_nop 1
    v_permlane16_swap_b32 v43, v44
    s_nop 0
    v_add_f32 v43, v43, v44
    v_mov_b32 v44, v43
    s_nop 1
    v_permlane32_swap_b32 v43, v44
    s_nop 0
    v_add_f32 v43, v43, v44
    v_mov_b32 v44, 0x3727c5ac
    v_fmac_f32 v44, 0x3ae38e39, v43
    v_rsq_f32 v44, v44
    s_nop 0
    v_mul_f32 v32, v32, v44
    v_mul_f32 v33, v33, v44
    v_mul_f32 v34, v34, v44
    v_mul_f32 v35, v35, v44
    v_mul_f32 v36, v36, v44
    v_mul_f32 v37, v37, v44
    v_mul_f32 v38, v38, v44
    v_mul_f32 v39, v39, v44
    v_mul_f32 v40, v40, v44
    v_mul_f32 v41, v41, v44
    v_cvt_pk_bf16_f32 v20, v32, v33
    v_cvt_pk_bf16_f32 v21, v34, v35
    v_cvt_pk_bf16_f32 v22, v36, v37
    v_cvt_pk_bf16_f32 v23, v38, v39
    v_cvt_pk_bf16_f32 v24, v40, v41
    v_add_u32 v12, 149504, v4
    ds_write_b128 v12, v[20:23]
    v_lshlrev_b32 v12, 2, v1
    v_add_u32 v12, 150528, v12
    s_mov_b32 exec_hi, 0
    ds_write_b32 v12, v24
    s_mov_b64 exec, -1
    v_bfe_u32 v12, v1, 2, 2
    v_lshl_add_u32 v12, v3, 2, v12
    v_lshlrev_b32 v12, 7, v12
    v_and_b32 v13, 3, v1
    v_lshl_add_u32 v12, v13, 3, v12
    s_lshl_b32 s40, s30, 5
    s_add_u32 s40, s40, 0
    v_add_u32 v12, s40, v12
    s_lshr_b32 s40, s29, 2
    s_mul_i32 s40, s40, 288
    s_add_u32 s40, s40, 149504
    v_lshlrev_b32 v13, 3, v3
    v_add_u32 v13, s40, v13
    s_waitcnt lgkmcnt(0)
    ds_read_b64 v[40:41], v13 offset:0
    ds_read_b64 v[42:43], v13 offset:32
    ds_read_b64 v[44:45], v13 offset:64
    ds_read_b64 v[46:47], v13 offset:96
    ds_read_b64 v[48:49], v13 offset:128
    ds_read_b64 v[50:51], v13 offset:160
    ds_read_b64 v[52:53], v13 offset:192
    ds_read_b64 v[54:55], v13 offset:224
    ds_read_b64 v[56:57], v13 offset:256
    v_mov_b32 v60, 0
    v_mov_b32 v61, 0
    v_mov_b32 v62, 0
    v_mov_b32 v63, 0
    s_lshr_b32 s40, s29, 2
    s_lshl_b32 s40, s40, 10
    s_and_b32 s41, s29, 3
    s_lshl_b32 s41, s41, 8
    s_add_u32 s40, s40, s41
    s_lshl_b32 s41, s28, 12
    s_add_u32 s40, s40, s41
    s_add_u32 s42, s26, s40
    s_addc_u32 s43, s27, 0
    s_mov_b32 s60, 0
LW_10:
    ds_read_b32 v14, v5
    s_add_u32 s60, s60, 1
    s_cmp_gt_u32 s60, 262144
    s_cbranch_scc1 LX_11
    s_waitcnt lgkmcnt(0)
    v_readfirstlane_b32 s31, v14
    s_cmp_lt_u32 s31, 1
    s_cbranch_scc1 LW_10
LX_11:
    s_waitcnt lgkmcnt(0)
    ds_read_b64_tr_b16 v[20:21], v12 offset:0
    ds_read_b64_tr_b16 v[22:23], v12 offset:2048
    ds_read_b64_tr_b16 v[24:25], v12 offset:4096
    ds_read_b64_tr_b16 v[26:27], v12 offset:6144
    ds_read_b64_tr_b16 v[28:29], v12 offset:8192
    ds_read_b64_tr_b16 v[30:31], v12 offset:10240
    ds_read_b64_tr_b16 v[32:33], v12 offset:12288
    ds_read_b64_tr_b16 v[34:35], v12 offset:14336
    ds_read_b64_tr_b16 v[36:37], v12 offset:16384
    s_waitcnt lgkmcnt(8)
    v_mfma_f32_16x16x16_bf16 v[60:63], v[20:21], v[40:41], v[60:63]
    s_waitcnt lgkmcnt(7)
    v_mfma_f32_16x16x16_bf16 v[60:63], v[22:23], v[42:43], v[60:63]
    s_waitcnt lgkmcnt(6)
    v_mfma_f32_16x16x16_bf16 v[60:63], v[24:25], v[44:45], v[60:63]
    s_waitcnt lgkmcnt(5)
    v_mfma_f32_16x16x16_bf16 v[60:63], v[26:27], v[46:47], v[60:63]
    s_waitcnt lgkmcnt(4)
    v_mfma_f32_16x16x16_bf16 v[60:63], v[28:29], v[48:49], v[60:63]
    s_waitcnt lgkmcnt(3)
    v_mfma_f32_16x16x16_bf16 v[60:63], v[30:31], v[50:51], v[60:63]
    s_waitcnt lgkmcnt(2)
    v_mfma_f32_16x16x16_bf16 v[60:63], v[32:33], v[52:53], v[60:63]
    s_waitcnt lgkmcnt(1)
    v_mfma_f32_16x16x16_bf16 v[60:63], v[34:35], v[54:55], v[60:63]
    s_waitcnt lgkmcnt(0)
    v_mfma_f32_16x16x16_bf16 v[60:63], v[36:37], v[56:57], v[60:63]
    s_lshl_b32 s40, s30, 6
    s_add_u32 s40, s40, 157760
    v_lshlrev_b32 v12, 4, v3
    v_add_u32 v12, s40, v12
    s_add_u32 s58, s58, 1
    s_and_b32 s56, s58, 0x3ff
    s_mov_b32 s57, 0xfffffc00
    v_mov_b32 v11, s56
    s_nop 0
    s_mov_b32 exec_lo, 0x10001
    s_mov_b32 exec_hi, 0x10001
    ds_write_b128 v12, v[60:63]
    s_mov_b64 exec, -1
    s_cmp_lg_u32 s30, 0
    s_cbranch_scc1 L_p1_done
    v_add_u32 v12, 157760, v4
    s_mov_b64 exec, 0xffff
    s_mov_b32 s60, 0
QP_12:
    ds_read_b128 v[60:63], v12
    s_add_u32 s60, s60, 1
    s_cmp_gt_u32 s60, 262144
    s_cbranch_scc1 QPX_13
    s_waitcnt lgkmcnt(0)
    v_max3_u32 v13, v60, v61, v62
    v_max_u32 v13, v13, v63
    v_cmp_eq_u32 vcc, -1, v13
    s_cbranch_vccnz QP_12
QPX_13:
    s_waitcnt lgkmcnt(0)
    v_and_or_b32 v60, v60, s57, v11
    v_and_or_b32 v61, v61, s57, v11
    v_and_or_b32 v62, v62, s57, v11
    v_and_or_b32 v63, v63, s57, v11
    s_mov_b64 s[48:49], s[42:43]
    s_getreg_b32 s59, hwreg(HW_REG_XCC_ID)
    s_and_b32 s59, s59, 7
    s_lshl_b32 s45, s58, 4
    s_or_b32 s45, s45, s59
    v_mov_b32 v49, s45
    s_lshl_b32 s40, s28, 6
    s_lshl_b32 s41, s29, 2
    s_add_u32 s40, s40, s41
    s_add_u32 s40, s40, 253952
    v_mov_b32 v48, s40
    s_waitcnt vmcnt(0)
    global_store_dwordx4 v4, v[60:63], s[48:49]
    s_mov_b64 exec, 1
    global_store_dword v48, v49, s[26:27]
    s_mov_b64 exec, -1
    s_cmp_ge_u32 s29, 9
    s_cbranch_scc1 XU_14
    v_lshlrev_b32 v216, 16, v196
    v_and_b32 v217, 0xffff0000, v196
    v_lshlrev_b32 v218, 16, v197
    v_and_b32 v219, 0xffff0000, v197
    v_lshlrev_b32 v220, 16, v198
    v_and_b32 v221, 0xffff0000, v198
    v_lshlrev_b32 v222, 16, v199
    v_and_b32 v223, 0xffff0000, v199
    v_lshlrev_b32 v224, 16, v200
    v_and_b32 v225, 0xffff0000, v200
    v_lshlrev_b32 v226, 16, v201
    v_and_b32 v227, 0xffff0000, v201
    v_lshlrev_b32 v228, 16, v202
    v_and_b32 v229, 0xffff0000, v202
    v_lshlrev_b32 v230, 16, v203
    v_and_b32 v231, 0xffff0000, v203
    v_lshlrev_b32 v232, 16, v204
    v_and_b32 v233, 0xffff0000, v204
    v_lshlrev_b32 v234, 16, v205
    v_and_b32 v235, 0xffff0000, v205
XU_14:
L_p1_done:
    v_and_b32 v13, 3, v2
    v_lshrrev_b32 v14, 2, v2
    v_lshl_add_u32 v15, v13, 2, v14
    v_lshlrev_b32 v15, 8, v15
    s_lshl_b32 s40, s30, 12
    s_add_u32 s40, s40, 18432
    v_add_u32 v15, s40, v15
    v_xor_b32 v13, v13, v3
    v_xor_b32 v16, 0, v14
    v_lshl_add_u32 v16, v16, 2, v13
    v_lshl_add_u32 v56, v16, 4, v15
    v_xor_b32 v16, 1, v14
    v_lshl_add_u32 v16, v16, 2, v13
    v_lshl_add_u32 v57, v16, 4, v15
    v_xor_b32 v16, 2, v14
    v_lshl_add_u32 v16, v16, 2, v13
    v_lshl_add_u32 v58, v16, 4, v15
    v_xor_b32 v16, 3, v14
    v_lshl_add_u32 v16, v16, 2, v13
    v_lshl_add_u32 v59, v16, 4, v15
    v_and_b32 v13, 1, v2
    v_cmp_eq_u32 vcc, 1, v13
    v_mov_b32 v14, 0xffff
    v_mov_b32 v16, 0xffff0000
    s_nop 0
    v_cndmask_b32 v14, v14, v16, vcc
    v_bfe_u32 v13, v2, 1, 2
    v_cmp_eq_u32 vcc, 0, v13
    s_nop 1
    v_cndmask_b32 v52, 0, v14, vcc
    v_cmp_eq_u32 vcc, 1, v13
    s_nop 1
    v_cndmask_b32 v53, 0, v14, vcc
    v_cmp_eq_u32 vcc, 2, v13
    s_nop 1
    v_cndmask_b32 v54, 0, v14, vcc
    v_cmp_eq_u32 vcc, 3, v13
    s_nop 1
    v_cndmask_b32 v55, 0, v14, vcc
    s_cmp_lg_u32 s30, 0
    s_cbranch_scc1 L_p2_skip
    s_mov_b32 s60, 0
LW_15:
    ds_read_b32 v14, v5 offset:24
    s_add_u32 s60, s60, 1
    s_cmp_gt_u32 s60, 262144
    s_cbranch_scc1 LX_16
    s_waitcnt lgkmcnt(0)
    v_readfirstlane_b32 s31, v14
    s_cmp_lt_u32 s31, 1
    s_cbranch_scc1 LW_15
LX_16:
    s_waitcnt lgkmcnt(0)
    s_lshl_b32 s40, s28, 12
    s_add_u32 s52, s26, s40
    s_addc_u32 s53, s27, 0
    s_mov_b32 s54, 0
    s_mov_b32 s55, 0
    s_lshl_b32 s40, s28, 6
    s_add_u32 s40, s40, 253952
    v_lshlrev_b32 v12, 2, v2
    v_add_u32 v12, s40, v12
    s_mov_b32 s60, 0
H1_17:
    s_bitcmp1_b32 s55, 0
    s_cbranch_scc0 H1N_19
    s_andn2_b32 s55, s55, 1
    s_mov_b32 s54, 1
    v_mov_b32 v28, -1
    v_mov_b32 v29, -1
    v_mov_b32 v30, -1
    v_mov_b32 v31, -1
    s_lshl_b32 s46, s28, 4
    s_add_u32 s46, s46, s29
    s_lshl_b32 s40, s46, 9
    s_add_u32 s40, s40, 98304
    s_add_u32 s42, s26, s40
    s_addc_u32 s43, s27, 0
    s_mov_b64 exec, -1
    s_mov_b32 exec_hi, 0
    global_store_dwordx4 v4, v[28:31], s[42:43] sc1
    s_mov_b64 exec, -1
    s_waitcnt vmcnt(0)
    v_or_b32 v49, 8, v49
    s_mov_b64 exec, 0xffff
    global_store_dwordx4 v4, v[60:63], s[48:49] sc1
    s_mov_b64 exec, 1
    global_store_dword v48, v49, s[26:27] sc1
    s_mov_b64 exec, -1
H1N_19:
    global_load_dwordx4 v[20:23], v4, s[52:53] offset:0 sc1
    global_load_dwordx4 v[24:27], v4, s[52:53] offset:1024 sc1
    global_load_dwordx4 v[28:31], v4, s[52:53] offset:2048 sc1
    global_load_dwordx4 v[32:35], v4, s[52:53] offset:3072 sc1
    global_load_dword v36, v12, s[26:27] sc1
    s_add_u32 s60, s60, 1
    s_cmp_gt_u32 s60, 32768
    s_cbranch_scc1 H1X_18
    s_waitcnt vmcnt(0)
    v_xor_b32 v40, v20, v11
    v_bitop3_b32 v40, v40, v21, v11 bitop3:0xf6
    v_bitop3_b32 v40, v40, v22, v11 bitop3:0xf6
    v_bitop3_b32 v40, v40, v23, v11 bitop3:0xf6
    v_bitop3_b32 v40, v40, v24, v11 bitop3:0xf6
    v_bitop3_b32 v40, v40, v25, v11 bitop3:0xf6
    v_bitop3_b32 v40, v40, v26, v11 bitop3:0xf6
    v_bitop3_b32 v40, v40, v27, v11 bitop3:0xf6
    v_bitop3_b32 v40, v40, v28, v11 bitop3:0xf6
    v_bitop3_b32 v40, v40, v29, v11 bitop3:0xf6
    v_bitop3_b32 v40, v40, v30, v11 bitop3:0xf6
    v_bitop3_b32 v40, v40, v31, v11 bitop3:0xf6
    v_bitop3_b32 v40, v40, v32, v11 bitop3:0xf6
    v_bitop3_b32 v40, v40, v33, v11 bitop3:0xf6
    v_bitop3_b32 v40, v40, v34, v11 bitop3:0xf6
    v_bitop3_b32 v40, v40, v35, v11 bitop3:0xf6
    v_and_b32 v40, 0x3ff, v40
    v_cmp_ne_u32 vcc, 0, v40
    s_and_b32 s40, s58, 0x0fffffff
    v_lshrrev_b32 v40, 4, v36
    v_cmp_ne_u32 s[44:45], s40, v40
    s_or_b64 vcc, vcc, s[44:45]
    s_cbranch_vccnz H1F_20
    v_and_b32 v40, 7, v36
    v_cmp_ne_u32 vcc, s59, v40
    s_cbranch_vccz H1X_18
    s_bitset1_b32 s55, 1
    s_cmp_lg_u32 s54, 0
    s_cbranch_scc1 H1G_21
    s_bitset1_b32 s55, 0
    s_branch H1_17
H1G_21:
    v_and_b32 v40, 8, v36
    v_cmp_eq_u32 vcc, 0, v40
    s_cbranch_vccz H1X_18
H1F_20:
    s_cmp_lg_u32 s60, 12
    s_cbranch_scc1 H1G_21x
    s_cmp_lg_u32 s54, 0
    s_cbranch_scc1 H1G_21x
    s_bitset1_b32 s55, 0
H1G_21x:
    s_branch H1_17
H1X_18:
    s_mov_b64 exec, -1
    s_waitcnt vmcnt(0)
    v_mov_b32 v40, s54
    s_mov_b64 exec, 1
    ds_write_b32 v5, v40 offset:28
    s_mov_b64 exec, -1
    v_add_f32 v36, v20, v24
    v_add_f32 v40, v28, v32
    v_add_f32 v36, v36, v40
    v_add_f32 v37, v21, v25
    v_add_f32 v41, v29, v33
    v_add_f32 v37, v37, v41
    v_add_f32 v38, v22, v26
    v_add_f32 v42, v30, v34
    v_add_f32 v38, v38, v42
    v_add_f32 v39, v23, v27
    v_add_f32 v43, v31, v35
    v_add_f32 v39, v39, v43
    v_cvt_pk_bf16_f32 v36, v36, v37
    v_cvt_pk_bf16_f32 v37, v38, v39
    v_lshlrev_b32 v12, 3, v1
    v_add_u32 v12, 150656, v12
    ds_write_b64 v12, v[36:37]
L_p2_skip:
    v_lshrrev_b32 v12, 3, v2
    v_lshlrev_b32 v12, 8, v12
    v_lshl_add_u32 v12, v3, 4, v12
    v_add_u32 v12, 150656, v12
    s_mov_b32 s60, 0
QF_22:
    ds_read_b128 v[20:23], v12 offset:0
    ds_read_b128 v[24:27], v12 offset:64
    ds_read_b128 v[28:31], v12 offset:128
    ds_read_b128 v[32:35], v12 offset:192
    s_add_u32 s60, s60, 1
    s_cmp_gt_u32 s60, 262144
    s_cbranch_scc1 QFX_23
    s_waitcnt lgkmcnt(0)
    v_max3_u32 v13, v20, v21, v22
    v_max3_u32 v13, v13, v23, v24
    v_max3_u32 v13, v13, v25, v26
    v_max3_u32 v13, v13, v27, v28
    v_max3_u32 v13, v13, v29, v30
    v_max3_u32 v13, v13, v31, v32
    v_max3_u32 v13, v13, v33, v34
    v_max_u32 v13, v13, v35
    v_cmp_eq_u32 vcc, -1, v13
    s_cbranch_vccnz QF_22
QFX_23:
    s_waitcnt lgkmcnt(0)
    s_mov_b32 s60, 0
LW_24:
    ds_read_b32 v14, v5
    s_add_u32 s60, s60, 1
    s_cmp_gt_u32 s60, 262144
    s_cbranch_scc1 LX_25
    s_waitcnt lgkmcnt(0)
    v_readfirstlane_b32 s31, v14
    s_cmp_lt_u32 s31, 2
    s_cbranch_scc1 LW_24
LX_25:
    s_waitcnt lgkmcnt(0)
    ds_read_b128 v[128:131], v56 offset:0
    ds_read_b128 v[132:135], v57 offset:0
    ds_read_b128 v[136:139], v58 offset:0
    ds_read_b128 v[140:143], v59 offset:0
    s_waitcnt lgkmcnt(3)
    v_mfma_f32_16x16x32_bf16 v[36:39], v[128:131], v[20:23], 0
    s_waitcnt lgkmcnt(2)
    v_mfma_f32_16x16x32_bf16 v[36:39], v[132:135], v[24:27], v[36:39]
    s_waitcnt lgkmcnt(1)
    v_mfma_f32_16x16x32_bf16 v[36:39], v[136:139], v[28:31], v[36:39]
    s_waitcnt lgkmcnt(0)
    v_mfma_f32_16x16x32_bf16 v[36:39], v[140:143], v[32:35], v[36:39]
    s_mov_b32 s60, 0
LW_26:
    ds_read_b32 v14, v5
    s_add_u32 s60, s60, 1
    s_cmp_gt_u32 s60, 262144
    s_cbranch_scc1 LX_27
    s_waitcnt lgkmcnt(0)
    v_readfirstlane_b32 s31, v14
    s_cmp_lt_u32 s31, 3
    s_cbranch_scc1 LW_26
LX_27:
    s_waitcnt lgkmcnt(0)
    ds_read_b128 v[144:147], v56 offset:16384
    ds_read_b128 v[148:151], v57 offset:16384
    ds_read_b128 v[152:155], v58 offset:16384
    ds_read_b128 v[156:159], v59 offset:16384
    s_waitcnt lgkmcnt(3)
    v_mfma_f32_16x16x32_bf16 v[40:43], v[144:147], v[20:23], 0
    s_waitcnt lgkmcnt(2)
    v_mfma_f32_16x16x32_bf16 v[40:43], v[148:151], v[24:27], v[40:43]
    s_waitcnt lgkmcnt(1)
    v_mfma_f32_16x16x32_bf16 v[40:43], v[152:155], v[28:31], v[40:43]
    s_waitcnt lgkmcnt(0)
    v_mfma_f32_16x16x32_bf16 v[40:43], v[156:159], v[32:35], v[40:43]
    s_mov_b32 s60, 0
LW_28:
    ds_read_b32 v14, v5
    s_add_u32 s60, s60, 1
    s_cmp_gt_u32 s60, 262144
    s_cbranch_scc1 LX_29
    s_waitcnt lgkmcnt(0)
    v_readfirstlane_b32 s31, v14
    s_cmp_lt_u32 s31, 4
    s_cbranch_scc1 LW_28
LX_29:
    s_waitcnt lgkmcnt(0)
    ds_read_b128 v[160:163], v56 offset:32768
    ds_read_b128 v[164:167], v57 offset:32768
    ds_read_b128 v[168:171], v58 offset:32768
    ds_read_b128 v[172:175], v59 offset:32768
    s_waitcnt lgkmcnt(3)
    v_mfma_f32_16x16x32_bf16 v[44:47], v[160:163], v[20:23], 0
    s_waitcnt lgkmcnt(2)
    v_mfma_f32_16x16x32_bf16 v[44:47], v[164:167], v[24:27], v[44:47]
    s_waitcnt lgkmcnt(1)
    v_mfma_f32_16x16x32_bf16 v[44:47], v[168:171], v[28:31], v[44:47]
    s_waitcnt lgkmcnt(0)
    v_mfma_f32_16x16x32_bf16 v[44:47], v[172:175], v[32:35], v[44:47]
    s_mov_b32 s60, 0
LW_30:
    ds_read_b32 v14, v5
    s_add_u32 s60, s60, 1
    s_cmp_gt_u32 s60, 262144
    s_cbranch_scc1 LX_31
    s_waitcnt lgkmcnt(0)
    v_readfirstlane_b32 s31, v14
    s_cmp_lt_u32 s31, 5
    s_cbranch_scc1 LW_30
LX_31:
    s_waitcnt lgkmcnt(0)
    ds_read_b128 v[176:179], v56 offset:49152
    ds_read_b128 v[180:183], v57 offset:49152
    ds_read_b128 v[184:187], v58 offset:49152
    ds_read_b128 v[188:191], v59 offset:49152
    s_waitcnt lgkmcnt(3)
    v_mfma_f32_16x16x32_bf16 v[48:51], v[176:179], v[20:23], 0
    s_waitcnt lgkmcnt(2)
    v_mfma_f32_16x16x32_bf16 v[48:51], v[180:183], v[24:27], v[48:51]
    s_waitcnt lgkmcnt(1)
    v_mfma_f32_16x16x32_bf16 v[48:51], v[184:187], v[28:31], v[48:51]
    s_waitcnt lgkmcnt(0)
    v_mfma_f32_16x16x32_bf16 v[48:51], v[188:191], v[32:35], v[48:51]
    v_mov_b32 v14, 1
    s_mov_b64 exec, 1
    ds_add_u32 v5, v14 offset:4
    s_mov_b64 exec, -1
    s_nop 7
    v_max3_f32 v13, v36, v37, v38
    v_max3_f32 v13, v13, v39, v40
    v_max3_f32 v13, v13, v41, v42
    v_max3_f32 v13, v13, v43, v44
    v_max3_f32 v13, v13, v45, v46
    v_max3_f32 v13, v13, v47, v48
    v_max3_f32 v13, v13, v49, v50
    v_max_f32 v13, v13, v51
    v_mov_b32 v14, v13
    s_nop 1
    v_permlane16_swap_b32 v13, v14
    s_nop 0
    v_max_f32 v13, v13, v14
    v_mov_b32 v14, v13
    s_nop 1
    v_permlane32_swap_b32 v13, v14
    s_nop 0
    v_max_f32 v13, v13, v14
    v_lshrrev_b32 v14, 3, v2
    v_lshlrev_b32 v14, 4, v14
    v_add_u32 v15, 151168, v14
    s_lshl_b32 s40, s30, 2
    v_add_u32 v16, s40, v15
    s_mov_b64 exec, 0x101
    ds_write_b32 v16, v13
    s_mov_b64 exec, -1
    s_mov_b32 s60, 0
MX_32:
    ds_read_b128 v[128:131], v15
    s_add_u32 s60, s60, 1
    s_cmp_gt_u32 s60, 262144
    s_cbranch_scc1 MXX_33
    s_waitcnt lgkmcnt(0)
    v_max3_u32 v17, v128, v129, v130
    v_max_u32 v17, v17, v131
    v_cmp_eq_u32 vcc, -1, v17
    s_cbranch_vccnz MX_32
MXX_33:
    s_waitcnt lgkmcnt(0)
    v_max3_f32 v13, v128, v129, v130
    v_max_f32 v13, v13, v131
    s_mov_b32 s44, 0x3e0293ee
    v_mul_f32 v17, s44, v13
    v_and_or_b32 v17, v17, s57, v11
    v_fma_f32 v36, v36, s44, -v17
    v_fma_f32 v37, v37, s44, -v17
    v_fma_f32 v38, v38, s44, -v17
    v_fma_f32 v39, v39, s44, -v17
    v_fma_f32 v40, v40, s44, -v17
    v_fma_f32 v41, v41, s44, -v17
    v_fma_f32 v42, v42, s44, -v17
    v_fma_f32 v43, v43, s44, -v17
    v_fma_f32 v44, v44, s44, -v17
    v_fma_f32 v45, v45, s44, -v17
    v_fma_f32 v46, v46, s44, -v17
    v_fma_f32 v47, v47, s44, -v17
    v_fma_f32 v48, v48, s44, -v17
    v_fma_f32 v49, v49, s44, -v17
    v_fma_f32 v50, v50, s44, -v17
    v_fma_f32 v51, v51, s44, -v17
    v_exp_f32 v36, v36
    v_exp_f32 v37, v37
    v_exp_f32 v38, v38
    v_exp_f32 v39, v39
    v_exp_f32 v40, v40
    v_exp_f32 v41, v41
    v_exp_f32 v42, v42
    v_exp_f32 v43, v43
    v_exp_f32 v44, v44
    v_exp_f32 v45, v45
    v_exp_f32 v46, v46
    v_exp_f32 v47, v47
    v_exp_f32 v48, v48
    v_exp_f32 v49, v49
    v_exp_f32 v50, v50
    v_exp_f32 v51, v51
    s_nop 0
    v_add_f32 v13, v36, v37
    v_add_f32 v13, v13, v38
    v_add_f32 v13, v13, v39
    v_add_f32 v13, v13, v40
    v_add_f32 v13, v13, v41
    v_add_f32 v13, v13, v42
    v_add_f32 v13, v13, v43
    v_add_f32 v13, v13, v44
    v_add_f32 v13, v13, v45
    v_add_f32 v13, v13, v46
    v_add_f32 v13, v13, v47
    v_add_f32 v13, v13, v48
    v_add_f32 v13, v13, v49
    v_add_f32 v13, v13, v50
    v_add_f32 v13, v13, v51
    v_mov_b32 v14, v13
    s_nop 1
    v_permlane16_swap_b32 v13, v14
    s_nop 0
    v_add_f32 v13, v13, v14
    v_mov_b32 v14, v13
    s_nop 1
    v_permlane32_swap_b32 v13, v14
    s_nop 0
    v_add_f32 v13, v13, v14
    v_add_u32 v16, 32, v16
    s_mov_b64 exec, 0x101
    ds_write_b32 v16, v13
    s_mov_b64 exec, -1
    s_cmp_lg_u32 s30, 3
    s_cbranch_scc1 L_p3_noml
    v_add_u32 v15, 32, v15
    s_mov_b32 s60, 0
LW_34:
    ds_read_b128 v[128:131], v15
    s_add_u32 s60, s60, 1
    s_cmp_gt_u32 s60, 262144
    s_cbranch_scc1 LWX_35
    s_waitcnt lgkmcnt(0)
    v_add_f32 v128, v128, v129
    v_add_f32 v130, v130, v131
    v_add_f32 v19, v128, v130
    v_cmp_u_f32 vcc, v19, v19
    s_cbranch_vccnz LW_34
LWX_35:
    s_waitcnt lgkmcnt(0)
    s_lshl_b32 s46, s28, 4
    s_add_u32 s40, s46, s29
    s_lshl_b32 s40, s40, 7
    s_add_u32 s40, s40, 65536
    s_add_u32 s42, s26, s40
    s_addc_u32 s43, s27, 0
    v_and_or_b32 v19, v19, s57, v11
    v_readlane_b32 s46, v17, 0
    v_readlane_b32 s47, v19, 0
    v_readlane_b32 s48, v17, 8
    v_readlane_b32 s49, v19, 8
    v_mov_b32 v28, s46
    v_mov_b32 v29, s47
    v_mov_b32 v30, s48
    v_mov_b32 v31, s49
    ds_read_b32 v14, v5 offset:28
    s_waitcnt lgkmcnt(0)
    v_readfirstlane_b32 s54, v14
    s_mov_b64 exec, 0xff
    s_cmp_lg_u32 s54, 0
    s_cbranch_scc1 MLG_36
    global_store_dwordx4 v4, v[28:31], s[42:43]
    s_branch MLD_37
MLG_36:
    global_store_dwordx4 v4, v[28:31], s[42:43] sc1
MLD_37:
    s_mov_b64 exec, -1
L_p3_noml:
    v_cvt_pk_bf16_f32 v36, v36, v36
    v_and_b32 v64, v36, v52
    v_and_b32 v65, v36, v53
    v_and_b32 v66, v36, v54
    v_and_b32 v67, v36, v55
    v_cvt_pk_bf16_f32 v37, v37, v37
    v_and_b32 v68, v37, v52
    v_and_b32 v69, v37, v53
    v_and_b32 v70, v37, v54
    v_and_b32 v71, v37, v55
    v_cvt_pk_bf16_f32 v38, v38, v38
    v_and_b32 v72, v38, v52
    v_and_b32 v73, v38, v53
    v_and_b32 v74, v38, v54
    v_and_b32 v75, v38, v55
    v_cvt_pk_bf16_f32 v39, v39, v39
    v_and_b32 v76, v39, v52
    v_and_b32 v77, v39, v53
    v_and_b32 v78, v39, v54
    v_and_b32 v79, v39, v55
    v_cvt_pk_bf16_f32 v40, v40, v40
    v_and_b32 v80, v40, v52
    v_and_b32 v81, v40, v53
    v_and_b32 v82, v40, v54
    v_and_b32 v83, v40, v55
    v_cvt_pk_bf16_f32 v41, v41, v41
    v_and_b32 v84, v41, v52
    v_and_b32 v85, v41, v53
    v_and_b32 v86, v41, v54
    v_and_b32 v87, v41, v55
    v_cvt_pk_bf16_f32 v42, v42, v42
    v_and_b32 v88, v42, v52
    v_and_b32 v89, v42, v53
    v_and_b32 v90, v42, v54
    v_and_b32 v91, v42, v55
    v_cvt_pk_bf16_f32 v43, v43, v43
    v_and_b32 v92, v43, v52
    v_and_b32 v93, v43, v53
    v_and_b32 v94, v43, v54
    v_and_b32 v95, v43, v55
    v_cvt_pk_bf16_f32 v44, v44, v44
    v_and_b32 v96, v44, v52
    v_and_b32 v97, v44, v53
    v_and_b32 v98, v44, v54
    v_and_b32 v99, v44, v55
    v_cvt_pk_bf16_f32 v45, v45, v45
    v_and_b32 v100, v45, v52
    v_and_b32 v101, v45, v53
    v_and_b32 v102, v45, v54
    v_and_b32 v103, v45, v55
    v_cvt_pk_bf16_f32 v46, v46, v46
    v_and_b32 v104, v46, v52
    v_and_b32 v105, v46, v53
    v_and_b32 v106, v46, v54
    v_and_b32 v107, v46, v55
    v_cvt_pk_bf16_f32 v47, v47, v47
    v_and_b32 v108, v47, v52
    v_and_b32 v109, v47, v53
    v_and_b32 v110, v47, v54
    v_and_b32 v111, v47, v55
    v_cvt_pk_bf16_f32 v48, v48, v48
    v_and_b32 v112, v48, v52
    v_and_b32 v113, v48, v53
    v_and_b32 v114, v48, v54
    v_and_b32 v115, v48, v55
    v_cvt_pk_bf16_f32 v49, v49, v49
    v_and_b32 v116, v49, v52
    v_and_b32 v117, v49, v53
    v_and_b32 v118, v49, v54
    v_and_b32 v119, v49, v55
    v_cvt_pk_bf16_f32 v50, v50, v50
    v_and_b32 v120, v50, v52
    v_and_b32 v121, v50, v53
    v_and_b32 v122, v50, v54
    v_and_b32 v123, v50, v55
    v_cvt_pk_bf16_f32 v51, v51, v51
    v_and_b32 v124, v51, v52
    v_and_b32 v125, v51, v53
    v_and_b32 v126, v51, v54
    v_and_b32 v127, v51, v55
    s_lshl_b32 s40, s30, 12
    s_add_u32 s40, s40, 83968
    v_add_u32 v12, s40, v4
    s_lshl_b32 s40, s28, 11
    s_add_u32 s40, s40, 65536
    s_add_u32 s42, s26, s40
    s_addc_u32 s43, s27, 0
    v_lshlrev_b32 v16, 7, v2
    v_mov_b32 v60, 0
    v_mov_b32 v61, 0
    v_mov_b32 v62, 0
    v_mov_b32 v63, 0
    s_lshl_b32 s40, s28, 4
    s_add_u32 s40, s40, s29
    s_lshl_b32 s40, s40, 9
    s_add_u32 s40, s40, 98304
    s_add_u32 s48, s26, s40
    s_addc_u32 s49, s27, 0
    v_lshrrev_b32 v9, 1, v3
    v_lshlrev_b32 v9, 8, v9
    v_lshl_add_u32 v9, v2, 4, v9
    s_mov_b32 s60, 0
LW_38:
    ds_read_b32 v14, v5
    s_add_u32 s60, s60, 1
    s_cmp_gt_u32 s60, 262144
    s_cbranch_scc1 LX_39
    s_waitcnt lgkmcnt(0)
    v_readfirstlane_b32 s31, v14
    s_cmp_lt_u32 s31, 6
    s_cbranch_scc1 LW_38
LX_39:
    s_waitcnt lgkmcnt(0)
    ds_read_b128 v[128:131], v12 offset:0
    ds_read_b128 v[132:135], v12 offset:1024
    ds_read_b128 v[136:139], v12 offset:2048
    ds_read_b128 v[140:143], v12 offset:3072
    s_cmp_lg_u32 s30, 3
    s_cbranch_scc1 MLI_40
    global_load_dwordx4 v[20:23], v16, s[42:43] sc1
MLI_40:
    s_waitcnt lgkmcnt(3)
    v_mfma_f32_16x16x32_bf16 v[60:63], v[64:67], v[128:131], v[60:63]
    s_waitcnt lgkmcnt(2)
    v_mfma_f32_16x16x32_bf16 v[60:63], v[68:71], v[132:135], v[60:63]
    s_waitcnt lgkmcnt(1)
    v_mfma_f32_16x16x32_bf16 v[60:63], v[72:75], v[136:139], v[60:63]
    s_waitcnt lgkmcnt(0)
    v_mfma_f32_16x16x32_bf16 v[60:63], v[76:79], v[140:143], v[60:63]
    s_mov_b32 s60, 0
LW_41:
    ds_read_b32 v14, v5
    s_add_u32 s60, s60, 1
    s_cmp_gt_u32 s60, 262144
    s_cbranch_scc1 LX_42
    s_waitcnt lgkmcnt(0)
    v_readfirstlane_b32 s31, v14
    s_cmp_lt_u32 s31, 7
    s_cbranch_scc1 LW_41
LX_42:
    s_waitcnt lgkmcnt(0)
    ds_read_b128 v[128:131], v12 offset:16384
    ds_read_b128 v[132:135], v12 offset:17408
    ds_read_b128 v[136:139], v12 offset:18432
    ds_read_b128 v[140:143], v12 offset:19456
    s_cmp_lg_u32 s30, 3
    s_cbranch_scc1 MLI_43
    global_load_dwordx4 v[32:35], v16, s[42:43] sc1
MLI_43:
    s_waitcnt lgkmcnt(3)
    v_mfma_f32_16x16x32_bf16 v[60:63], v[80:83], v[128:131], v[60:63]
    s_waitcnt lgkmcnt(2)
    v_mfma_f32_16x16x32_bf16 v[60:63], v[84:87], v[132:135], v[60:63]
    s_waitcnt lgkmcnt(1)
    v_mfma_f32_16x16x32_bf16 v[60:63], v[88:91], v[136:139], v[60:63]
    s_waitcnt lgkmcnt(0)
    v_mfma_f32_16x16x32_bf16 v[60:63], v[92:95], v[140:143], v[60:63]
    s_mov_b32 s60, 0
LW_44:
    ds_read_b32 v14, v5
    s_add_u32 s60, s60, 1
    s_cmp_gt_u32 s60, 262144
    s_cbranch_scc1 LX_45
    s_waitcnt lgkmcnt(0)
    v_readfirstlane_b32 s31, v14
    s_cmp_lt_u32 s31, 8
    s_cbranch_scc1 LW_44
LX_45:
    s_waitcnt lgkmcnt(0)
    ds_read_b128 v[128:131], v12 offset:32768
    ds_read_b128 v[132:135], v12 offset:33792
    ds_read_b128 v[136:139], v12 offset:34816
    ds_read_b128 v[140:143], v12 offset:35840
    s_cmp_lg_u32 s30, 3
    s_cbranch_scc1 MLI_46
    global_load_dwordx4 v[36:39], v16, s[42:43] sc1
MLI_46:
    s_waitcnt lgkmcnt(3)
    v_mfma_f32_16x16x32_bf16 v[60:63], v[96:99], v[128:131], v[60:63]
    s_waitcnt lgkmcnt(2)
    v_mfma_f32_16x16x32_bf16 v[60:63], v[100:103], v[132:135], v[60:63]
    s_waitcnt lgkmcnt(1)
    v_mfma_f32_16x16x32_bf16 v[60:63], v[104:107], v[136:139], v[60:63]
    s_waitcnt lgkmcnt(0)
    v_mfma_f32_16x16x32_bf16 v[60:63], v[108:111], v[140:143], v[60:63]
    s_cmp_lg_u32 s30, 3
    s_cbranch_scc1 MLS_47
    s_mov_b32 s62, 0
    s_waitcnt vmcnt(2)
    v_xor_b32 v14, v20, v11
    v_bitop3_b32 v14, v14, v21, v11 bitop3:0xf6
    v_bitop3_b32 v14, v14, v22, v11 bitop3:0xf6
    v_bitop3_b32 v14, v14, v23, v11 bitop3:0xf6
    v_and_b32 v14, 0x3ff, v14
    v_cmp_ne_u32 vcc, 0, v14
    s_cbranch_vccz MLM_48
    s_waitcnt vmcnt(1)
    v_xor_b32 v14, v32, v11
    v_bitop3_b32 v14, v14, v33, v11 bitop3:0xf6
    v_bitop3_b32 v14, v14, v34, v11 bitop3:0xf6
    v_bitop3_b32 v14, v14, v35, v11 bitop3:0xf6
    v_and_b32 v14, 0x3ff, v14
    v_cmp_ne_u32 vcc, 0, v14
    v_mov_b32 v20, v32
    v_mov_b32 v21, v33
    v_mov_b32 v22, v34
    v_mov_b32 v23, v35
    s_cbranch_vccz MLM_48
    s_mov_b32 s62, 1
    s_branch MLK_49
MLM_48:
    v_mov_b32 v24, v20
    v_mov_b32 v25, v22
    s_nop 0
    v_max_f32_dpp v24, v24, v24 quad_perm:[1,0,3,2] row_mask:0xf bank_mask:0xf
    v_max_f32_dpp v25, v25, v25 quad_perm:[1,0,3,2] row_mask:0xf bank_mask:0xf
    s_nop 0
    v_max_f32_dpp v24, v24, v24 quad_perm:[2,3,0,1] row_mask:0xf bank_mask:0xf
    v_max_f32_dpp v25, v25, v25 quad_perm:[2,3,0,1] row_mask:0xf bank_mask:0xf
    s_nop 0
    v_max_f32_dpp v24, v24, v24 row_half_mirror row_mask:0xf bank_mask:0xf
    v_max_f32_dpp v25, v25, v25 row_half_mirror row_mask:0xf bank_mask:0xf
    s_nop 0
    v_max_f32_dpp v24, v24, v24 row_mirror row_mask:0xf bank_mask:0xf
    v_max_f32_dpp v25, v25, v25 row_mirror row_mask:0xf bank_mask:0xf
    v_sub_f32 v26, v20, v24
    v_sub_f32 v27, v22, v25
    v_exp_f32 v26, v26
    v_exp_f32 v27, v27
    v_readlane_b32 s44, v17, 0
    v_readlane_b32 s45, v17, 8
    v_mul_f32 v26, v26, v21
    v_mul_f32 v27, v27, v23
    s_nop 0
    v_add_f32_dpp v26, v26, v26 quad_perm:[1,0,3,2] row_mask:0xf bank_mask:0xf
    v_add_f32_dpp v27, v27, v27 quad_perm:[1,0,3,2] row_mask:0xf bank_mask:0xf
    s_nop 0
    v_add_f32_dpp v26, v26, v26 quad_perm:[2,3,0,1] row_mask:0xf bank_mask:0xf
    v_add_f32_dpp v27, v27, v27 quad_perm:[2,3,0,1] row_mask:0xf bank_mask:0xf
    s_nop 0
    v_add_f32_dpp v26, v26, v26 row_half_mirror row_mask:0xf bank_mask:0xf
    v_add_f32_dpp v27, v27, v27 row_half_mirror row_mask:0xf bank_mask:0xf
    s_nop 0
    v_add_f32_dpp v26, v26, v26 row_mirror row_mask:0xf bank_mask:0xf
    v_add_f32_dpp v27, v27, v27 row_mirror row_mask:0xf bank_mask:0xf
    v_sub_f32 v24, s44, v24
    v_sub_f32 v25, s45, v25
    v_rcp_f32 v26, v26
    v_rcp_f32 v27, v27
    v_exp_f32 v24, v24
    v_exp_f32 v25, v25
    s_nop 0
    v_mul_f32 v24, v24, v26
    v_mul_f32 v25, v25, v27
    s_mov_b32 exec_lo, 0
    v_mov_b32 v24, v25
    s_mov_b64 exec, -1
MLK_49:
MLS_47:
    s_mov_b32 s60, 0
LW_50:
    ds_read_b32 v14, v5
    s_add_u32 s60, s60, 1
    s_cmp_gt_u32 s60, 262144
    s_cbranch_scc1 LX_51
    s_waitcnt lgkmcnt(0)
    v_readfirstlane_b32 s31, v14
    s_cmp_lt_u32 s31, 9
    s_cbranch_scc1 LW_50
LX_51:
    s_waitcnt lgkmcnt(0)
    ds_read_b128 v[128:131], v12 offset:49152
    ds_read_b128 v[132:135], v12 offset:50176
    ds_read_b128 v[136:139], v12 offset:51200
    ds_read_b128 v[140:143], v12 offset:52224
    s_waitcnt lgkmcnt(3)
    v_mfma_f32_16x16x32_bf16 v[60:63], v[112:115], v[128:131], v[60:63]
    s_waitcnt lgkmcnt(2)
    v_mfma_f32_16x16x32_bf16 v[60:63], v[116:119], v[132:135], v[60:63]
    s_waitcnt lgkmcnt(1)
    v_mfma_f32_16x16x32_bf16 v[60:63], v[120:123], v[136:139], v[60:63]
    s_waitcnt lgkmcnt(0)
    v_mfma_f32_16x16x32_bf16 v[60:63], v[124:127], v[140:143], v[60:63]
    v_mov_b32 v14, 1
    s_mov_b64 exec, 1
    ds_add_u32 v5, v14 offset:8
    s_mov_b64 exec, -1
    s_cmp_eq_u32 s30, 3
    s_cbranch_scc1 L_p4_pub
    s_lshl_b32 s40, s30, 10
    s_add_u32 s40, s40, 151232
    v_add_u32 v12, s40, v4
    ds_write_b128 v12, v[60:63]
    s_branch L_p4_done
L_p4_pub:
    s_cmp_eq_u32 s62, 0
    s_cbranch_scc1 MLD_52
    s_waitcnt vmcnt(0)
    v_mov_b32 v20, v36
    v_mov_b32 v21, v37
    v_mov_b32 v22, v38
    v_mov_b32 v23, v39
    s_mov_b32 s61, 0
    s_branch ML_53_chk
ML_53:
    global_load_dwordx4 v[20:23], v16, s[42:43] sc1
ML_53_chk:
    s_add_u32 s61, s61, 1
    s_cmp_gt_u32 s61, 32768
    s_cbranch_scc1 MLX_54
    s_waitcnt vmcnt(0)
    v_xor_b32 v14, v20, v11
    v_bitop3_b32 v14, v14, v21, v11 bitop3:0xf6
    v_bitop3_b32 v14, v14, v22, v11 bitop3:0xf6
    v_bitop3_b32 v14, v14, v23, v11 bitop3:0xf6
    v_and_b32 v14, 0x3ff, v14
    v_cmp_ne_u32 vcc, 0, v14
    s_cbranch_vccz MLX_54
    s_sleep 2
    s_branch ML_53
MLX_54:
    s_waitcnt vmcnt(0)
    v_mov_b32 v24, v20
    v_mov_b32 v25, v22
    s_nop 0
    v_max_f32_dpp v24, v24, v24 quad_perm:[1,0,3,2] row_mask:0xf bank_mask:0xf
    v_max_f32_dpp v25, v25, v25 quad_perm:[1,0,3,2] row_mask:0xf bank_mask:0xf
    s_nop 0
    v_max_f32_dpp v24, v24, v24 quad_perm:[2,3,0,1] row_mask:0xf bank_mask:0xf
    v_max_f32_dpp v25, v25, v25 quad_perm:[2,3,0,1] row_mask:0xf bank_mask:0xf
    s_nop 0
    v_max_f32_dpp v24, v24, v24 row_half_mirror row_mask:0xf bank_mask:0xf
    v_max_f32_dpp v25, v25, v25 row_half_mirror row_mask:0xf bank_mask:0xf
    s_nop 0
    v_max_f32_dpp v24, v24, v24 row_mirror row_mask:0xf bank_mask:0xf
    v_max_f32_dpp v25, v25, v25 row_mirror row_mask:0xf bank_mask:0xf
    v_sub_f32 v26, v20, v24
    v_sub_f32 v27, v22, v25
    v_exp_f32 v26, v26
    v_exp_f32 v27, v27
    v_readlane_b32 s44, v17, 0
    v_readlane_b32 s45, v17, 8
    v_mul_f32 v26, v26, v21
    v_mul_f32 v27, v27, v23
    s_nop 0
    v_add_f32_dpp v26, v26, v26 quad_perm:[1,0,3,2] row_mask:0xf bank_mask:0xf
    v_add_f32_dpp v27, v27, v27 quad_perm:[1,0,3,2] row_mask:0xf bank_mask:0xf
    s_nop 0
    v_add_f32_dpp v26, v26, v26 quad_perm:[2,3,0,1] row_mask:0xf bank_mask:0xf
    v_add_f32_dpp v27, v27, v27 quad_perm:[2,3,0,1] row_mask:0xf bank_mask:0xf
    s_nop 0
    v_add_f32_dpp v26, v26, v26 row_half_mirror row_mask:0xf bank_mask:0xf
    v_add_f32_dpp v27, v27, v27 row_half_mirror row_mask:0xf bank_mask:0xf
    s_nop 0
    v_add_f32_dpp v26, v26, v26 row_mirror row_mask:0xf bank_mask:0xf
    v_add_f32_dpp v27, v27, v27 row_mirror row_mask:0xf bank_mask:0xf
    v_sub_f32 v24, s44, v24
    v_sub_f32 v25, s45, v25
    v_rcp_f32 v26, v26
    v_rcp_f32 v27, v27
    v_exp_f32 v24, v24
    v_exp_f32 v25, v25
    s_nop 0
    v_mul_f32 v24, v24, v26
    v_mul_f32 v25, v25, v27
    s_mov_b32 exec_lo, 0
    v_mov_b32 v24, v25
    s_mov_b64 exec, -1
MLD_52:
    v_add_u32 v12, 151232, v4
    s_mov_b32 s60, 0
OP_55:
    ds_read_b128 v[128:131], v12 offset:0
    ds_read_b128 v[132:135], v12 offset:1024
    ds_read_b128 v[136:139], v12 offset:2048
    s_add_u32 s60, s60, 1
    s_cmp_gt_u32 s60, 262144
    s_cbranch_scc1 OPX_56
    s_waitcnt lgkmcnt(0)
    v_add_f32 v140, v128, v132
    v_add_f32 v140, v140, v136
    v_add_f32 v141, v129, v133
    v_add_f32 v141, v141, v137
    v_add_f32 v142, v130, v134
    v_add_f32 v142, v142, v138
    v_add_f32 v143, v131, v135
    v_add_f32 v143, v143, v139
    v_add_f32 v15, v140, v141
    v_add_f32 v16, v142, v143
    v_add_f32 v15, v15, v16
    v_cmp_u_f32 vcc, v15, v15
    s_cbranch_vccnz OP_55
OPX_56:
    s_waitcnt lgkmcnt(0)
    v_add_f32 v60, v60, v140
    v_mul_f32 v60, v60, v24
    v_add_f32 v61, v61, v141
    v_mul_f32 v61, v61, v24
    v_add_f32 v62, v62, v142
    v_mul_f32 v62, v62, v24
    v_add_f32 v63, v63, v143
    v_mul_f32 v63, v63, v24
    v_cvt_pk_bf16_f32 v28, v60, v61
    v_cvt_pk_bf16_f32 v29, v62, v63
    v_mov_b32 v30, v28
    v_mov_b32 v31, v29
    s_nop 0
    v_permlane16_swap_b32 v28, v30
    v_permlane16_swap_b32 v29, v31
    s_nop 1
    s_mov_b32 exec_lo, 0xffff
    s_mov_b32 exec_hi, 0xffff
    s_cmp_lg_u32 s54, 0
    s_cbranch_scc1 PUBG_57
    global_store_dwordx4 v9, v[28:31], s[48:49]
    s_branch PUBD_58
PUBG_57:
    global_store_dwordx4 v9, v[28:31], s[48:49] sc1
PUBD_58:
    s_mov_b64 exec, -1
    v_mov_b32 v14, 1
    s_mov_b64 exec, 1
    ds_write_b32 v5, v14 offset:44
    s_mov_b64 exec, -1
L_p4_done:
    s_cmp_lt_u32 s29, 9
    s_cbranch_scc1 L_role_f
    s_cmp_eq_u32 s29, 15
    s_cbranch_scc1 L_p5_done
    s_lshl_b32 s40, s28, 13
    s_add_u32 s40, s40, 98304
    s_add_u32 s42, s26, s40
    s_addc_u32 s43, s27, 0
    v_lshlrev_b32 v12, 9, v2
    v_lshl_add_u32 v12, v3, 4, v12
    s_lshl_b32 s40, s30, 7
    v_add_u32 v12, s40, v12
    v_bfe_u32 v14, v1, 2, 2
    v_lshl_add_u32 v14, v3, 3, v14
    s_lshl_b32 s40, s30, 6
    v_add_u32 v14, s40, v14
    v_mul_u32_u24 v14, 192, v14
    v_and_b32 v15, 3, v1
    v_lshl_add_u32 v14, v15, 3, v14
    s_mov_b32 s60, 0
LW_59:
    ds_read_b32 v16, v5 offset:12
    s_add_u32 s60, s60, 1
    s_cmp_gt_u32 s60, 262144
    s_cbranch_scc1 LX_60
    s_waitcnt lgkmcnt(0)
    v_readfirstlane_b32 s31, v16
    s_cmp_lt_u32 s31, 1
    s_cbranch_scc1 LW_59
LX_60:
    s_waitcnt lgkmcnt(0)
    s_mov_b32 s62, 0
    s_mov_b32 s61, 0
H2_61:
    global_load_dwordx4 v[20:23], v12, s[42:43] offset:0 sc1
    global_load_dwordx4 v[24:27], v12, s[42:43] offset:64 sc1
    s_cmp_lg_u32 s62, 0
    s_cbranch_scc1 H2F_63
    s_mov_b32 s62, 1
    v_mov_b32 v16, 1
    s_mov_b64 exec, 1
    ds_add_u32 v5, v16 offset:16
    s_mov_b64 exec, -1
    s_and_b32 s63, s29, 1
    s_lshl_b32 s63, s63, 1
    s_add_u32 s63, s63, s30
    s_and_b32 s63, s63, 3
    s_add_u32 s63, s63, 10
    s_mov_b32 s60, 0
LW_64:
    ds_read_b32 v16, v5
    s_add_u32 s60, s60, 1
    s_cmp_gt_u32 s60, 262144
    s_cbranch_scc1 LX_65
    s_waitcnt lgkmcnt(0)
    v_readfirstlane_b32 s31, v16
    s_cmp_lt_u32 s31, s63
    s_cbranch_scc1 LW_64
LX_65:
    s_waitcnt lgkmcnt(0)
    ds_read_b64_tr_b16 v[64:65], v14 offset:0
    ds_read_b64_tr_b16 v[66:67], v14 offset:768
    ds_read_b64_tr_b16 v[72:73], v14 offset:32
    ds_read_b64_tr_b16 v[74:75], v14 offset:800
    ds_read_b64_tr_b16 v[80:81], v14 offset:64
    ds_read_b64_tr_b16 v[82:83], v14 offset:832
    ds_read_b64_tr_b16 v[88:89], v14 offset:96
    ds_read_b64_tr_b16 v[90:91], v14 offset:864
    ds_read_b64_tr_b16 v[96:97], v14 offset:128
    ds_read_b64_tr_b16 v[98:99], v14 offset:896
    ds_read_b64_tr_b16 v[104:105], v14 offset:160
    ds_read_b64_tr_b16 v[106:107], v14 offset:928
    ds_read_b64_tr_b16 v[68:69], v14 offset:6144
    ds_read_b64_tr_b16 v[70:71], v14 offset:6912
    ds_read_b64_tr_b16 v[76:77], v14 offset:6176
    ds_read_b64_tr_b16 v[78:79], v14 offset:6944
    ds_read_b64_tr_b16 v[84:85], v14 offset:6208
    ds_read_b64_tr_b16 v[86:87], v14 offset:6976
    ds_read_b64_tr_b16 v[92:93], v14 offset:6240
    ds_read_b64_tr_b16 v[94:95], v14 offset:7008
    ds_read_b64_tr_b16 v[100:101], v14 offset:6272
    ds_read_b64_tr_b16 v[102:103], v14 offset:7040
    ds_read_b64_tr_b16 v[108:109], v14 offset:6304
    ds_read_b64_tr_b16 v[110:111], v14 offset:7072
H2F_63:
    s_add_u32 s61, s61, 1
    s_cmp_gt_u32 s61, 32768
    s_cbranch_scc1 H2X_62
    s_waitcnt vmcnt(0)
    v_max3_u32 v16, v20, v21, v22
    v_max3_u32 v16, v16, v23, v24
    v_max3_u32 v16, v16, v25, v26
    v_max_u32 v16, v16, v27
    v_cmp_eq_u32 vcc, -1, v16
    s_and_b64 exec, exec, vcc
    s_cbranch_execz H2X_62
    s_branch H2_61
H2X_62:
    s_mov_b64 exec, -1
    s_waitcnt vmcnt(0) lgkmcnt(0)
    v_mfma_f32_16x16x32_bf16 v[112:115], v[20:23], v[64:67], 0
    v_mfma_f32_16x16x32_bf16 v[116:119], v[20:23], v[72:75], 0
    v_mfma_f32_16x16x32_bf16 v[120:123], v[20:23], v[80:83], 0
    v_mfma_f32_16x16x32_bf16 v[124:127], v[20:23], v[88:91], 0
    v_mfma_f32_16x16x32_bf16 v[128:131], v[20:23], v[96:99], 0
    v_mfma_f32_16x16x32_bf16 v[132:135], v[20:23], v[104:107], 0
    v_mfma_f32_16x16x32_bf16 v[112:115], v[24:27], v[68:71], v[112:115]
    v_mfma_f32_16x16x32_bf16 v[116:119], v[24:27], v[76:79], v[116:119]
    v_mfma_f32_16x16x32_bf16 v[120:123], v[24:27], v[84:87], v[120:123]
    v_mfma_f32_16x16x32_bf16 v[124:127], v[24:27], v[92:95], v[124:127]
    v_mfma_f32_16x16x32_bf16 v[128:131], v[24:27], v[100:103], v[128:131]
    v_mfma_f32_16x16x32_bf16 v[132:135], v[24:27], v[108:111], v[132:135]
    s_nop 3
    v_add_f32 v112, v112, v113
    v_add_f32 v114, v114, v115
    v_add_f32 v112, v112, v114
    v_add_f32 v116, v116, v117
    v_add_f32 v118, v118, v119
    v_add_f32 v116, v116, v118
    v_add_f32 v120, v120, v121
    v_add_f32 v122, v122, v123
    v_add_f32 v120, v120, v122
    v_add_f32 v124, v124, v125
    v_add_f32 v126, v126, v127
    v_add_f32 v124, v124, v126
    v_add_f32 v128, v128, v129
    v_add_f32 v130, v130, v131
    v_add_f32 v128, v128, v130
    s_nop 3
    v_add_f32 v132, v132, v133
    v_add_f32 v134, v134, v135
    v_add_f32 v132, v132, v134
    v_mov_b32 v113, 0
    v_mov_b32 v114, 0
    s_nop 1
    v_permlane32_swap_b32 v112, v120
    v_permlane32_swap_b32 v116, v124
    v_permlane32_swap_b32 v128, v113
    v_permlane32_swap_b32 v132, v114
    s_nop 0
    v_add_f32 v112, v112, v120
    v_add_f32 v116, v116, v124
    v_add_f32 v128, v128, v113
    v_add_f32 v132, v132, v114
    s_nop 1
    v_permlane16_swap_b32 v112, v116
    v_permlane16_swap_b32 v128, v132
    s_nop 0
    v_add_f32 v112, v112, v116
    v_add_f32 v128, v128, v132
    s_lshl_b32 s40, s30, 9
    s_add_u32 s40, s40, 154304
    v_lshlrev_b32 v12, 2, v1
    v_add_u32 v12, s40, v12
    ds_write_b32 v12, v112
    ds_write_b32 v12, v128 offset:256
    s_cmp_lg_u32 s30, 3
    s_cbranch_scc1 L_p5_done
    v_lshlrev_b32 v12, 5, v1
    v_add_u32 v12, 154304, v12
    s_sub_u32 s41, s29, 9
    s_mov_b64 exec, 0xfff
    s_mov_b32 s60, 0
R5_66:
    ds_read_b128 v[64:67], v12 offset:0
    ds_read_b128 v[68:71], v12 offset:16
    ds_read_b128 v[72:75], v12 offset:512
    ds_read_b128 v[76:79], v12 offset:528
    ds_read_b128 v[80:83], v12 offset:1024
    ds_read_b128 v[84:87], v12 offset:1040
    ds_read_b128 v[88:91], v12 offset:1536
    ds_read_b128 v[92:95], v12 offset:1552
    s_add_u32 s60, s60, 1
    s_cmp_gt_u32 s60, 262144
    s_cbranch_scc1 R5X_67
    s_waitcnt lgkmcnt(0)
    v_add_f32 v20, v64, v72
    v_add_f32 v96, v80, v88
    v_add_f32 v20, v20, v96
    v_add_f32 v21, v65, v73
    v_add_f32 v97, v81, v89
    v_add_f32 v21, v21, v97
    v_add_f32 v22, v66, v74
    v_add_f32 v98, v82, v90
    v_add_f32 v22, v22, v98
    v_add_f32 v23, v67, v75
    v_add_f32 v99, v83, v91
    v_add_f32 v23, v23, v99
    v_add_f32 v24, v68, v76
    v_add_f32 v100, v84, v92
    v_add_f32 v24, v24, v100
    v_add_f32 v25, v69, v77
    v_add_f32 v101, v85, v93
    v_add_f32 v25, v25, v101
    v_add_f32 v26, v70, v78
    v_add_f32 v102, v86, v94
    v_add_f32 v26, v26, v102
    v_add_f32 v27, v71, v79
    v_add_f32 v103, v87, v95
    v_add_f32 v27, v27, v103
    v_add_f32 v15, v20, v21
    v_add_f32 v15, v15, v22
    v_add_f32 v15, v15, v23
    v_add_f32 v15, v15, v24
    v_add_f32 v15, v15, v25
    v_add_f32 v15, v15, v26
    v_add_f32 v15, v15, v27
    v_cmp_u_f32 vcc, v15, v15
    s_cbranch_vccnz R5_66
R5X_67:
    s_waitcnt lgkmcnt(0)
    v_cvt_pk_bf16_f32 v20, v20, v21
    v_cvt_pk_bf16_f32 v21, v22, v23
    v_cvt_pk_bf16_f32 v22, v24, v25
    v_cvt_pk_bf16_f32 v23, v26, v27
    s_mul_i32 s40, s41, 192
    s_mul_i32 s44, s28, 1152
    s_add_u32 s40, s40, s44
    s_add_u32 s40, s40, 229376
    s_add_u32 s42, s26, s40
    s_addc_u32 s43, s27, 0
    global_store_dwordx4 v4, v[20:23], s[42:43] sc1
    s_mov_b64 exec, -1
L_p5_done:
    s_cmp_ge_u32 s30, 1
    s_cbranch_scc1 L_fin
    s_lshr_b32 s40, s28, 1
    s_and_b32 s44, s28, 1
    s_sub_u32 s41, s29, 9
    s_lshl_b32 s41, s41, 1
    s_add_u32 s41, s41, s44
    s_cmp_lt_u32 s41, 8
    s_cbranch_scc1 L_p9_go
    s_cmp_ge_u32 s41, 12
    s_cbranch_scc1 L_fin
    s_cmp_ge_u32 s40, 2
    s_cbranch_scc1 L_fin
L_p9_go:
    s_lshr_b32 s44, s41, 2
    s_lshl_b32 s44, s44, 3
    s_add_u32 s44, s44, s40
    s_lshl_b32 s44, s44, 5
    s_and_b32 s45, s41, 3
    s_lshl_b32 s45, s45, 3
    s_add_u32 s44, s44, s45
    v_lshrrev_b32 v9, 2, v1
    v_lshlrev_b32 v9, 7, v9
    v_and_b32 v14, 3, v1
    v_lshl_add_u32 v9, v14, 3, v9
    v_add_u32 v9, 249856, v9
    s_lshl_b32 s40, s44, 1
    s_add_u32 s40, s40, 229376
    s_add_u32 s42, s26, s40
    s_addc_u32 s43, s27, 0
    v_mul_u32_u24 v12, 1152, v2
    v_lshl_add_u32 v12, v3, 1, v12
    s_lshl_b32 s40, s44, 1
    s_add_u32 s46, s4, s40
    s_addc_u32 s47, s5, 0
    v_lshlrev_b32 v13, 1, v3
    global_load_ushort v26, v13, s[46:47]
    global_load_ushort v27, v13, s[46:47] offset:8
    s_mov_b32 s60, 0
HH_68:
    global_load_dwordx2 v[18:19], v9, s[26:27] sc1
    global_load_ushort v24, v12, s[42:43] sc1
    global_load_ushort v25, v12, s[42:43] offset:8 sc1
    s_add_u32 s60, s60, 1
    s_cmp_gt_u32 s60, 32768
    s_cbranch_scc1 HHX_69
    s_waitcnt vmcnt(0)
    v_cmp_ne_u32 s[50:51], s58, v18
    v_cmp_ne_u32 s[40:41], s58, v19
    s_or_b64 s[50:51], s[50:51], s[40:41]
    v_max_u32 v28, v24, v25
    v_cmp_eq_u32 vcc, 0xffff, v28
    s_or_b64 vcc, vcc, s[50:51]
    s_cbranch_vccz HHX_69
    s_sleep 4
    s_branch HH_68
HHX_69:
    s_waitcnt vmcnt(0)
    v_lshlrev_b32 v24, 16, v24
    v_lshlrev_b32 v25, 16, v25
    v_lshlrev_b32 v26, 16, v26
    v_lshlrev_b32 v27, 16, v27
    s_nop 0
    v_add_f32_dpp v24, v24, v24 quad_perm:[1,0,3,2] row_mask:0xf bank_mask:0xf
    v_add_f32_dpp v25, v25, v25 quad_perm:[1,0,3,2] row_mask:0xf bank_mask:0xf
    s_nop 0
    v_add_f32_dpp v24, v24, v24 quad_perm:[2,3,0,1] row_mask:0xf bank_mask:0xf
    v_add_f32_dpp v25, v25, v25 quad_perm:[2,3,0,1] row_mask:0xf bank_mask:0xf
    s_nop 0
    v_add_f32_dpp v24, v24, v24 row_half_mirror row_mask:0xf bank_mask:0xf
    v_add_f32_dpp v25, v25, v25 row_half_mirror row_mask:0xf bank_mask:0xf
    s_nop 0
    v_add_f32_dpp v24, v24, v24 row_mirror row_mask:0xf bank_mask:0xf
    v_add_f32_dpp v25, v25, v25 row_mirror row_mask:0xf bank_mask:0xf
    v_add_f32 v24, v24, v26
    v_add_f32 v25, v25, v27
    s_mov_b32 exec_lo, 0xaaaaaaaa
    s_mov_b32 exec_hi, 0xaaaaaaaa
    v_mov_b32 v24, v25
    s_mov_b64 exec, -1
    s_lshl_b32 s40, s44, 2
    s_add_u32 s40, s40, 262144
    s_add_u32 s42, s26, s40
    s_addc_u32 s43, s27, 0
    v_lshrrev_b32 v12, 1, v1
    v_mul_u32_u24 v12, 2304, v12
    v_and_b32 v13, 1, v1
    v_lshl_add_u32 v12, v13, 4, v12
    v_add_u32 v13, 73728, v12
    v_add_u32 v14, 147456, v12
    v_add_u32 v15, 221184, v12
    v_add_u32 v16, 294912, v12
    v_mov_b32 v80, v11
    v_mov_b32 v81, v11
    v_mov_b32 v82, v11
    v_mov_b32 v83, v11
    s_lshl_b32 s40, s44, 1
    s_add_u32 s48, s22, s40
    s_addc_u32 s49, s23, 0
    v_and_b32 v10, 1, v1
    v_lshlrev_b32 v10, 3, v10
    v_lshl_add_u32 v10, v3, 1, v10
    v_mov_b32 v100, v11
    v_mov_b32 v101, v11
    v_mov_b32 v102, v11
    v_mov_b32 v103, v11
    s_mov_b32 s60, 0
    global_load_dwordx4 v[64:67], v12, s[42:43] sc1
    global_load_dwordx4 v[68:71], v13, s[42:43] sc1
    global_load_dwordx4 v[72:75], v14, s[42:43] sc1
    global_load_dwordx4 v[76:79], v15, s[42:43] sc1
    s_mov_b32 exec_hi, 0
    global_load_dwordx4 v[80:83], v16, s[42:43] sc1
    s_mov_b64 exec, -1
    global_load_dwordx4 v[84:87], v12, s[42:43] sc1
    global_load_dwordx4 v[88:91], v13, s[42:43] sc1
    global_load_dwordx4 v[92:95], v14, s[42:43] sc1
    global_load_dwordx4 v[96:99], v15, s[42:43] sc1
    s_mov_b32 exec_hi, 0
    global_load_dwordx4 v[100:103], v16, s[42:43] sc1
    s_mov_b64 exec, -1
H4_70:
    s_waitcnt vmcnt(5)
    v_xor_b32 v28, v64, v11
    v_bitop3_b32 v28, v28, v65, v11 bitop3:0xf6
    v_bitop3_b32 v28, v28, v66, v11 bitop3:0xf6
    v_bitop3_b32 v28, v28, v67, v11 bitop3:0xf6
    v_bitop3_b32 v28, v28, v68, v11 bitop3:0xf6
    v_bitop3_b32 v28, v28, v69, v11 bitop3:0xf6
    v_bitop3_b32 v28, v28, v70, v11 bitop3:0xf6
    v_bitop3_b32 v28, v28, v71, v11 bitop3:0xf6
    v_bitop3_b32 v28, v28, v72, v11 bitop3:0xf6
    v_bitop3_b32 v28, v28, v73, v11 bitop3:0xf6
    v_bitop3_b32 v28, v28, v74, v11 bitop3:0xf6
    v_bitop3_b32 v28, v28, v75, v11 bitop3:0xf6
    v_bitop3_b32 v28, v28, v76, v11 bitop3:0xf6
    v_bitop3_b32 v28, v28, v77, v11 bitop3:0xf6
    v_bitop3_b32 v28, v28, v78, v11 bitop3:0xf6
    v_bitop3_b32 v28, v28, v79, v11 bitop3:0xf6
    v_bitop3_b32 v28, v28, v80, v11 bitop3:0xf6
    v_bitop3_b32 v28, v28, v81, v11 bitop3:0xf6
    v_bitop3_b32 v28, v28, v82, v11 bitop3:0xf6
    v_bitop3_b32 v28, v28, v83, v11 bitop3:0xf6
    v_and_b32 v28, 0x3ff, v28
    v_cmp_ne_u32 vcc, 0, v28
    s_cbranch_vccz H4A_71
    global_load_dwordx4 v[64:67], v12, s[42:43] sc1
    global_load_dwordx4 v[68:71], v13, s[42:43] sc1
    global_load_dwordx4 v[72:75], v14, s[42:43] sc1
    global_load_dwordx4 v[76:79], v15, s[42:43] sc1
    s_mov_b32 exec_hi, 0
    global_load_dwordx4 v[80:83], v16, s[42:43] sc1
    s_mov_b64 exec, -1
    s_waitcnt vmcnt(5)
    v_xor_b32 v28, v84, v11
    v_bitop3_b32 v28, v28, v85, v11 bitop3:0xf6
    v_bitop3_b32 v28, v28, v86, v11 bitop3:0xf6
    v_bitop3_b32 v28, v28, v87, v11 bitop3:0xf6
    v_bitop3_b32 v28, v28, v88, v11 bitop3:0xf6
    v_bitop3_b32 v28, v28, v89, v11 bitop3:0xf6
    v_bitop3_b32 v28, v28, v90, v11 bitop3:0xf6
    v_bitop3_b32 v28, v28, v91, v11 bitop3:0xf6
    v_bitop3_b32 v28, v28, v92, v11 bitop3:0xf6
    v_bitop3_b32 v28, v28, v93, v11 bitop3:0xf6
    v_bitop3_b32 v28, v28, v94, v11 bitop3:0xf6
    v_bitop3_b32 v28, v28, v95, v11 bitop3:0xf6
    v_bitop3_b32 v28, v28, v96, v11 bitop3:0xf6
    v_bitop3_b32 v28, v28, v97, v11 bitop3:0xf6
    v_bitop3_b32 v28, v28, v98, v11 bitop3:0xf6
    v_bitop3_b32 v28, v28, v99, v11 bitop3:0xf6
    v_bitop3_b32 v28, v28, v100, v11 bitop3:0xf6
    v_bitop3_b32 v28, v28, v101, v11 bitop3:0xf6
    v_bitop3_b32 v28, v28, v102, v11 bitop3:0xf6
    v_bitop3_b32 v28, v28, v103, v11 bitop3:0xf6
    v_and_b32 v28, 0x3ff, v28
    v_cmp_ne_u32 vcc, 0, v28
    s_cbranch_vccz H4B_72
    global_load_dwordx4 v[84:87], v12, s[42:43] sc1
    global_load_dwordx4 v[88:91], v13, s[42:43] sc1
    global_load_dwordx4 v[92:95], v14, s[42:43] sc1
    global_load_dwordx4 v[96:99], v15, s[42:43] sc1
    s_mov_b32 exec_hi, 0
    global_load_dwordx4 v[100:103], v16, s[42:43] sc1
    s_mov_b64 exec, -1
    s_add_u32 s60, s60, 1
    s_cmp_le_u32 s60, 32768
    s_cbranch_scc1 H4_70
    s_waitcnt vmcnt(0)
H4A_71:
    v_add_f32 v20, v64, v68
    v_add_f32 v28, v72, v76
    v_add_f32 v20, v20, v80
    v_add_f32 v20, v20, v28
    v_add_f32 v21, v65, v69
    v_add_f32 v29, v73, v77
    v_add_f32 v21, v21, v81
    v_add_f32 v21, v21, v29
    v_add_f32 v22, v66, v70
    v_add_f32 v30, v74, v78
    v_add_f32 v22, v22, v82
    v_add_f32 v22, v22, v30
    v_add_f32 v23, v67, v71
    v_add_f32 v31, v75, v79
    v_add_f32 v23, v23, v83
    v_add_f32 v23, v23, v31
    s_branch H4D_73
H4B_72:
    v_add_f32 v20, v84, v88
    v_add_f32 v28, v92, v96
    v_add_f32 v20, v20, v100
    v_add_f32 v20, v20, v28
    v_add_f32 v21, v85, v89
    v_add_f32 v29, v93, v97
    v_add_f32 v21, v21, v101
    v_add_f32 v21, v21, v29
    v_add_f32 v22, v86, v90
    v_add_f32 v30, v94, v98
    v_add_f32 v22, v22, v102
    v_add_f32 v22, v22, v30
    v_add_f32 v23, v87, v91
    v_add_f32 v31, v95, v99
    v_add_f32 v23, v23, v103
    v_add_f32 v23, v23, v31
H4D_73:
    s_nop 1
    v_permlane32_swap_b32 v20, v22
    v_permlane32_swap_b32 v21, v23
    s_nop 0
    v_add_f32 v20, v20, v22
    v_add_f32 v21, v21, v23
    s_nop 1
    v_permlane16_swap_b32 v20, v21
    s_nop 0
    v_add_f32 v20, v20, v21
    s_nop 1
    v_add_f32_dpp v20, v20, v20 row_ror:8 row_mask:0xf bank_mask:0xf
    s_nop 1
    v_add_f32_dpp v20, v20, v20 row_ror:4 row_mask:0xf bank_mask:0xf
    s_nop 1
    v_add_f32_dpp v20, v20, v20 row_ror:2 row_mask:0xf bank_mask:0xf
    v_add_f32 v20, v20, v24
    v_cvt_pk_bf16_f32 v20, v20, v20
    s_mov_b32 exec_lo, 0x30003
    s_mov_b32 exec_hi, 0x30003
    global_store_short v10, v20, s[48:49]
    s_mov_b64 exec, -1
    s_or_b32 s40, s44, s30
    s_cmp_lg_u32 s40, 0
    s_cbranch_scc1 L_fin
    v_mov_b32 v12, 258048
    v_mov_b32 v13, s58
    s_mov_b64 exec, 1
    global_store_dword v12, v13, s[26:27]
    s_mov_b64 exec, -1
    s_branch L_fin
L_role_f:
    s_mov_b32 s60, 0
LW_74:
    ds_read_b32 v14, v5 offset:40
    s_add_u32 s60, s60, 1
    s_cmp_gt_u32 s60, 262144
    s_cbranch_scc1 LX_75
    s_waitcnt lgkmcnt(0)
    v_readfirstlane_b32 s31, v14
    s_cmp_lt_u32 s31, 1
    s_cbranch_scc1 LW_74
LX_75:
    s_waitcnt lgkmcnt(0)
    s_cmp_eq_u32 s31, 2
    s_cselect_b32 s98, 0, 83968
    s_cselect_b32 s99, 83968, 0
    s_cmp_ge_u32 s31, 2
    s_cselect_b32 s100, 10, 11
    s_cselect_b32 s101, 11, 12
    s_cselect_b32 s53, 12, 10
    v_bfe_u32 v12, v1, 2, 2
    v_lshl_add_u32 v12, v3, 3, v12
    v_lshlrev_b32 v12, 6, v12
    v_and_b32 v13, 3, v1
    v_lshl_add_u32 v12, v13, 3, v12
    s_and_b32 s40, s30, 1
    s_lshl_b32 s40, s40, 5
    s_cmp_ge_u32 s30, 2
    s_cselect_b32 s41, s98, 36864
    s_add_u32 s40, s40, s41
    v_add_u32 v12, s40, v12
    v_bfe_u32 v10, v1, 2, 2
    v_lshl_add_u32 v10, v3, 3, v10
    v_mul_u32_u24 v10, 1152, v10
    v_and_b32 v14, 3, v1
    v_lshlrev_b32 v14, 3, v14
    s_mul_i32 s40, s30, 320
    s_add_u32 s40, s40, s99
    v_add_u32 v14, s40, v14
    v_add_u32 v10, v10, v14
    s_cmp_eq_u32 s30, 3
    s_cselect_b32 s40, 64, 0
    v_subrev_u32 v10, s40, v10
    v_xor_b32 v6, 0, v2
    v_add_u32 v6, -1, v6
    v_ashrrev_i32 v6, 31, v6
    v_xor_b32 v7, 1, v2
    v_add_u32 v7, -1, v7
    v_ashrrev_i32 v7, 31, v7
    v_xor_b32 v8, 2, v2
    v_add_u32 v8, -1, v8
    v_ashrrev_i32 v8, 31, v8
    v_xor_b32 v30, 3, v2
    v_add_u32 v30, -1, v30
    v_ashrrev_i32 v30, 31, v30
    v_xor_b32 v31, 4, v2
    v_add_u32 v31, -1, v31
    v_ashrrev_i32 v31, 31, v31
    v_xor_b32 v60, 5, v2
    v_add_u32 v60, -1, v60
    v_ashrrev_i32 v60, 31, v60
    v_xor_b32 v61, 6, v2
    v_add_u32 v61, -1, v61
    v_ashrrev_i32 v61, 31, v61
    v_xor_b32 v62, 7, v2
    v_add_u32 v62, -1, v62
    v_ashrrev_i32 v62, 31, v62
    v_xor_b32 v63, 8, v2
    v_add_u32 v63, -1, v63
    v_ashrrev_i32 v63, 31, v63
    v_xor_b32 v0, 9, v2
    v_add_u32 v0, -1, v0
    v_ashrrev_i32 v0, 31, v0
    s_cmp_lg_u32 s30, 0
    s_cbranch_scc1 L_p6_skip
    v_and_b32 v56, 0x3f803f80, v52
    v_and_b32 v57, 0x3f803f80, v53
    v_and_b32 v58, 0x3f803f80, v54
    v_and_b32 v59, 0x3f803f80, v55
    v_mov_b32 v200, 0
    v_mov_b32 v201, 0
    v_mov_b32 v202, 0
    v_mov_b32 v203, 0
    v_mov_b32 v204, 0
    v_mov_b32 v205, 0
    v_mov_b32 v206, 0
    v_mov_b32 v207, 0
    v_mov_b32 v208, 0
    v_mov_b32 v209, 0
    v_mov_b32 v210, 0
    v_mov_b32 v211, 0
    v_mov_b32 v212, 0
    v_mov_b32 v213, 0
    v_mov_b32 v214, 0
    v_mov_b32 v215, 0
    s_add_u32 s42, s26, 229376
    s_addc_u32 s43, s27, 0
    v_mul_u32_u24 v13, 1152, v3
    v_lshl_add_u32 v13, v2, 4, v13
    s_mov_b32 s60, 0
LW_76:
    ds_read_b32 v14, v5
    s_add_u32 s60, s60, 1
    s_cmp_gt_u32 s60, 262144
    s_cbranch_scc1 LX_77
    s_waitcnt lgkmcnt(0)
    v_readfirstlane_b32 s31, v14
    s_cmp_lt_u32 s31, s100
    s_cbranch_scc1 LW_76
LX_77:
    s_waitcnt lgkmcnt(0)
    ds_read_b64_tr_b16 v[64:65], v12 offset:0
    ds_read_b64_tr_b16 v[66:67], v12 offset:256
    ds_read_b64_tr_b16 v[68:69], v12 offset:2048
    ds_read_b64_tr_b16 v[70:71], v12 offset:2304
    ds_read_b64_tr_b16 v[72:73], v12 offset:4096
    ds_read_b64_tr_b16 v[74:75], v12 offset:4352
    ds_read_b64_tr_b16 v[76:77], v12 offset:6144
    ds_read_b64_tr_b16 v[78:79], v12 offset:6400
    ds_read_b64_tr_b16 v[80:81], v12 offset:8192
    ds_read_b64_tr_b16 v[82:83], v12 offset:8448
    ds_read_b64_tr_b16 v[84:85], v12 offset:10240
    ds_read_b64_tr_b16 v[86:87], v12 offset:10496
    ds_read_b64_tr_b16 v[88:89], v12 offset:12288
    ds_read_b64_tr_b16 v[90:91], v12 offset:12544
    ds_read_b64_tr_b16 v[92:93], v12 offset:14336
    ds_read_b64_tr_b16 v[94:95], v12 offset:14592
    ds_read_b64_tr_b16 v[96:97], v12 offset:16384
    ds_read_b64_tr_b16 v[98:99], v12 offset:16640
    ds_read_b64_tr_b16 v[100:101], v12 offset:18432
    ds_read_b64_tr_b16 v[102:103], v12 offset:18688
    ds_read_b64_tr_b16 v[104:105], v12 offset:20480
    ds_read_b64_tr_b16 v[106:107], v12 offset:20736
    ds_read_b64_tr_b16 v[108:109], v12 offset:22528
    ds_read_b64_tr_b16 v[110:111], v12 offset:22784
    ds_read_b64_tr_b16 v[112:113], v12 offset:24576
    ds_read_b64_tr_b16 v[114:115], v12 offset:24832
    ds_read_b64_tr_b16 v[116:117], v12 offset:26624
    ds_read_b64_tr_b16 v[118:119], v12 offset:26880
    ds_read_b64_tr_b16 v[120:121], v12 offset:28672
    ds_read_b64_tr_b16 v[122:123], v12 offset:28928
    ds_read_b64_tr_b16 v[124:125], v12 offset:30720
    ds_read_b64_tr_b16 v[126:127], v12 offset:30976
    ds_read_b64_tr_b16 v[128:129], v12 offset:32768
    ds_read_b64_tr_b16 v[130:131], v12 offset:33024
    ds_read_b64_tr_b16 v[132:133], v12 offset:34816
    ds_read_b64_tr_b16 v[134:135], v12 offset:35072
    v_lshrrev_b32 v9, 2, v1
    v_lshlrev_b32 v9, 7, v9
    v_and_b32 v14, 3, v1
    v_lshl_add_u32 v9, v14, 3, v9
    v_add_u32 v9, 249856, v9
    s_mov_b32 s60, 0
LW_78:
    ds_read_b32 v14, v5 offset:12
    s_add_u32 s60, s60, 1
    s_cmp_gt_u32 s60, 262144
    s_cbranch_scc1 LX_79
    s_waitcnt lgkmcnt(0)
    v_readfirstlane_b32 s31, v14
    s_cmp_lt_u32 s31, 1
    s_cbranch_scc1 LW_78
LX_79:
    s_waitcnt lgkmcnt(0)
    s_mov_b64 s[46:47], -1
    s_mov_b32 s61, 0
H3_80:
    s_mov_b64 exec, -1
    global_load_dwordx2 v[18:19], v9, s[26:27] sc1
    s_mov_b64 exec, s[46:47]
    s_mov_b32 s44, s42
    s_mov_b32 s45, s43
    global_load_dwordx4 v[136:139], v13, s[44:45] offset:0 sc1
    global_load_dwordx4 v[152:155], v13, s[44:45] offset:256 sc1
    global_load_dwordx4 v[168:171], v13, s[44:45] offset:512 sc1
    global_load_dwordx4 v[184:187], v13, s[44:45] offset:768 sc1
    s_and_b32 exec_lo, exec_lo, 0x00ff00ff
    s_and_b32 exec_hi, exec_hi, 0x00ff00ff
    s_cbranch_execz H3Z_82
    global_load_dwordx4 v[200:203], v13, s[44:45] offset:1024 sc1
H3Z_82:
    s_mov_b64 exec, s[46:47]
    s_add_u32 s44, s44, 4608
    s_addc_u32 s45, s45, 0
    global_load_dwordx4 v[140:143], v13, s[44:45] offset:0 sc1
    global_load_dwordx4 v[156:159], v13, s[44:45] offset:256 sc1
    global_load_dwordx4 v[172:175], v13, s[44:45] offset:512 sc1
    global_load_dwordx4 v[188:191], v13, s[44:45] offset:768 sc1
    s_and_b32 exec_lo, exec_lo, 0x00ff00ff
    s_and_b32 exec_hi, exec_hi, 0x00ff00ff
    s_cbranch_execz H3Z_83
    global_load_dwordx4 v[204:207], v13, s[44:45] offset:1024 sc1
H3Z_83:
    s_mov_b64 exec, s[46:47]
    s_add_u32 s44, s44, 4608
    s_addc_u32 s45, s45, 0
    global_load_dwordx4 v[144:147], v13, s[44:45] offset:0 sc1
    global_load_dwordx4 v[160:163], v13, s[44:45] offset:256 sc1
    global_load_dwordx4 v[176:179], v13, s[44:45] offset:512 sc1
    global_load_dwordx4 v[192:195], v13, s[44:45] offset:768 sc1
    s_and_b32 exec_lo, exec_lo, 0x00ff00ff
    s_and_b32 exec_hi, exec_hi, 0x00ff00ff
    s_cbranch_execz H3Z_84
    global_load_dwordx4 v[208:211], v13, s[44:45] offset:1024 sc1
H3Z_84:
    s_mov_b64 exec, s[46:47]
    s_add_u32 s44, s44, 4608
    s_addc_u32 s45, s45, 0
    global_load_dwordx4 v[148:151], v13, s[44:45] offset:0 sc1
    global_load_dwordx4 v[164:167], v13, s[44:45] offset:256 sc1
    global_load_dwordx4 v[180:183], v13, s[44:45] offset:512 sc1
    global_load_dwordx4 v[196:199], v13, s[44:45] offset:768 sc1
    s_and_b32 exec_lo, exec_lo, 0x00ff00ff
    s_and_b32 exec_hi, exec_hi, 0x00ff00ff
    s_cbranch_execz H3Z_85
    global_load_dwordx4 v[212:215], v13, s[44:45] offset:1024 sc1
H3Z_85:
    s_mov_b64 exec, s[46:47]
    s_add_u32 s44, s44, 4608
    s_addc_u32 s45, s45, 0
    s_mov_b64 exec, -1
    s_cmp_lg_u32 s61, 0
    s_cbranch_scc1 H3H_86
    v_mov_b32 v14, 1
    s_mov_b64 exec, 1
    ds_write_b32 v5, v14 offset:16
    s_mov_b64 exec, -1
H3H_86:
    s_add_u32 s61, s61, 1
    s_cmp_gt_u32 s61, 32768
    s_cbranch_scc1 H3X_81
    s_cmp_le_u32 s61, 1
    s_cbranch_scc1 H3W_87
    s_waitcnt vmcnt(0)
    v_max3_u32 v14, v136, v152, v168
    v_max3_u32 v14, v14, v184, v200
    v_max3_u32 v14, v14, v140, v156
    v_max3_u32 v14, v14, v172, v188
    v_max3_u32 v14, v14, v204, v144
    v_max3_u32 v14, v14, v160, v176
    v_max3_u32 v14, v14, v192, v208
    v_max3_u32 v14, v14, v148, v164
    v_max3_u32 v14, v14, v180, v196
    v_max_u32 v14, v14, v212
    v_cmp_ne_u32 s[50:51], s58, v18
    v_cmp_ne_u32 s[40:41], s58, v19
    s_or_b64 s[50:51], s[50:51], s[40:41]
    v_cmp_eq_u32 vcc, -1, v14
    s_cmp_lg_u64 s[50:51], 0
    s_cbranch_scc0 H3Q_88
    s_mov_b64 vcc, -1
H3Q_88:
    s_cbranch_vccz H3W_87
    s_mov_b64 s[46:47], vcc
    s_mov_b64 exec, vcc
    s_branch H3_80
H3W_87:
    s_waitcnt vmcnt(15)
    v_cmp_ne_u32 s[50:51], s58, v18
    v_cmp_ne_u32 s[40:41], s58, v19
    s_or_b64 s[50:51], s[50:51], s[40:41]
    v_mfma_f32_16x16x32_bf16 v[236:239], v[56:59], v[136:139], v[216:219]
    v_mfma_f32_16x16x32_bf16 v[240:243], v[56:59], v[152:155], v[220:223]
    v_mfma_f32_16x16x32_bf16 v[244:247], v[56:59], v[168:171], v[224:227]
    v_mfma_f32_16x16x32_bf16 v[248:251], v[56:59], v[184:187], v[228:231]
    v_mfma_f32_16x16x32_bf16 v[252:255], v[56:59], v[200:203], v[232:235]
    s_waitcnt vmcnt(10)
    v_mfma_f32_16x16x32_bf16 v[236:239], v[56:59], v[140:143], v[236:239]
    v_mfma_f32_16x16x32_bf16 v[240:243], v[56:59], v[156:159], v[240:243]
    v_mfma_f32_16x16x32_bf16 v[244:247], v[56:59], v[172:175], v[244:247]
    v_mfma_f32_16x16x32_bf16 v[248:251], v[56:59], v[188:191], v[248:251]
    v_mfma_f32_16x16x32_bf16 v[252:255], v[56:59], v[204:207], v[252:255]
    s_waitcnt vmcnt(5)
    v_mfma_f32_16x16x32_bf16 v[236:239], v[56:59], v[144:147], v[236:239]
    v_mfma_f32_16x16x32_bf16 v[240:243], v[56:59], v[160:163], v[240:243]
    v_mfma_f32_16x16x32_bf16 v[244:247], v[56:59], v[176:179], v[244:247]
    v_mfma_f32_16x16x32_bf16 v[248:251], v[56:59], v[192:195], v[248:251]
    v_mfma_f32_16x16x32_bf16 v[252:255], v[56:59], v[208:211], v[252:255]
    s_waitcnt vmcnt(0)
    v_mfma_f32_16x16x32_bf16 v[236:239], v[56:59], v[148:151], v[236:239]
    v_mfma_f32_16x16x32_bf16 v[240:243], v[56:59], v[164:167], v[240:243]
    v_mfma_f32_16x16x32_bf16 v[244:247], v[56:59], v[180:183], v[244:247]
    v_mfma_f32_16x16x32_bf16 v[248:251], v[56:59], v[196:199], v[248:251]
    v_mfma_f32_16x16x32_bf16 v[252:255], v[56:59], v[212:215], v[252:255]
    s_nop 3
    v_pk_add_f32 v[14:15], v[236:237], v[238:239]
    v_pk_mul_f32 v[16:17], v[236:237], v[236:237]
    v_pk_fma_f32 v[16:17], v[238:239], v[238:239], v[16:17]
    v_pk_add_f32 v[14:15], v[14:15], v[240:241]
    v_pk_fma_f32 v[16:17], v[240:241], v[240:241], v[16:17]
    v_pk_add_f32 v[14:15], v[14:15], v[242:243]
    v_pk_fma_f32 v[16:17], v[242:243], v[242:243], v[16:17]
    v_pk_add_f32 v[14:15], v[14:15], v[244:245]
    v_pk_fma_f32 v[16:17], v[244:245], v[244:245], v[16:17]
    v_pk_add_f32 v[14:15], v[14:15], v[246:247]
    v_pk_fma_f32 v[16:17], v[246:247], v[246:247], v[16:17]
    v_pk_add_f32 v[14:15], v[14:15], v[248:249]
    v_pk_fma_f32 v[16:17], v[248:249], v[248:249], v[16:17]
    v_pk_add_f32 v[14:15], v[14:15], v[250:251]
    v_pk_fma_f32 v[16:17], v[250:251], v[250:251], v[16:17]
    s_nop 3
    v_pk_add_f32 v[14:15], v[14:15], v[252:253]
    v_pk_fma_f32 v[16:17], v[252:253], v[252:253], v[16:17]
    v_pk_add_f32 v[14:15], v[14:15], v[254:255]
    v_pk_fma_f32 v[16:17], v[254:255], v[254:255], v[16:17]
    v_add_f32 v14, v14, v15
    v_add_f32 v16, v16, v17
    v_cmp_u_f32 vcc, v14, v14
    s_cmp_lg_u64 s[50:51], 0
    s_cbranch_scc0 H3R_89
    s_mov_b64 vcc, -1
H3R_89:
    s_cbranch_vccz H3X_81
    s_mov_b64 s[46:47], vcc
    s_mov_b64 exec, s[46:47]
    s_branch H3_80
H3X_81:
    s_mov_b64 exec, -1
    s_waitcnt vmcnt(0) lgkmcnt(0)
    s_nop 0
    v_add_f32_dpp v14, v14, v14 quad_perm:[1,0,3,2] row_mask:0xf bank_mask:0xf
    v_add_f32_dpp v16, v16, v16 quad_perm:[1,0,3,2] row_mask:0xf bank_mask:0xf
    s_nop 0
    v_add_f32_dpp v14, v14, v14 quad_perm:[2,3,0,1] row_mask:0xf bank_mask:0xf
    v_add_f32_dpp v16, v16, v16 quad_perm:[2,3,0,1] row_mask:0xf bank_mask:0xf
    s_nop 0
    v_add_f32_dpp v14, v14, v14 row_half_mirror row_mask:0xf bank_mask:0xf
    v_add_f32_dpp v16, v16, v16 row_half_mirror row_mask:0xf bank_mask:0xf
    s_nop 0
    v_add_f32_dpp v14, v14, v14 row_mirror row_mask:0xf bank_mask:0xf
    v_add_f32_dpp v16, v16, v16 row_mirror row_mask:0xf bank_mask:0xf
    v_mov_b32 v15, v14
    v_mov_b32 v17, v16
    s_nop 0
    v_permlane16_swap_b32 v14, v15
    v_permlane16_swap_b32 v16, v17
    s_nop 0
    v_add_f32 v14, v14, v15
    v_add_f32 v16, v16, v17
    v_mul_f32 v14, 0x3ae38e39, v14
    v_mul_f32 v16, 0x3ae38e39, v16
    v_fma_f32 v16, -v14, v14, v16
    v_max_f32 v16, 0, v16
    v_add_f32 v16, 0x3727c5ac, v16
    v_rsq_f32 v16, v16
    v_and_b32 v13, 1, v3
    v_lshlrev_b32 v13, 3, v13
    v_lshl_add_u32 v13, v2, 4, v13
    v_add_u32 v13, 156352, v13
    v_mul_f32 v14, v14, v16
    v_mov_b32 v17, v16
    v_sub_f32 v14, 0, v14
    v_mov_b32 v15, v14
    s_mov_b32 exec_hi, 0
    v_pk_fma_f32 v[236:237], v[236:237], v[16:17], v[14:15]
    v_pk_fma_f32 v[238:239], v[238:239], v[16:17], v[14:15]
    v_cvt_pk_bf16_f32 v20, v236, v237
    v_cvt_pk_bf16_f32 v21, v238, v239
    ds_write_b64 v13, v[20:21] offset:0
    v_pk_fma_f32 v[240:241], v[240:241], v[16:17], v[14:15]
    v_pk_fma_f32 v[242:243], v[242:243], v[16:17], v[14:15]
    v_cvt_pk_bf16_f32 v22, v240, v241
    v_cvt_pk_bf16_f32 v23, v242, v243
    ds_write_b64 v13, v[22:23] offset:256
    v_pk_fma_f32 v[244:245], v[244:245], v[16:17], v[14:15]
    v_pk_fma_f32 v[246:247], v[246:247], v[16:17], v[14:15]
    v_cvt_pk_bf16_f32 v24, v244, v245
    v_cvt_pk_bf16_f32 v25, v246, v247
    ds_write_b64 v13, v[24:25] offset:512
    v_pk_fma_f32 v[248:249], v[248:249], v[16:17], v[14:15]
    v_pk_fma_f32 v[250:251], v[250:251], v[16:17], v[14:15]
    v_cvt_pk_bf16_f32 v26, v248, v249
    v_cvt_pk_bf16_f32 v27, v250, v251
    ds_write_b64 v13, v[26:27] offset:768
    v_pk_fma_f32 v[252:253], v[252:253], v[16:17], v[14:15]
    v_pk_fma_f32 v[254:255], v[254:255], v[16:17], v[14:15]
    v_cvt_pk_bf16_f32 v28, v252, v253
    v_cvt_pk_bf16_f32 v29, v254, v255
    s_mov_b32 exec_lo, 0x00ff00ff
    ds_write_b64 v13, v[28:29] offset:1024
    s_mov_b64 exec, -1
    v_mov_b32 v14, 1
    s_mov_b64 exec, 1
    ds_write_b32 v5, v14 offset:20
    s_mov_b64 exec, -1
    s_branch L_p7_go
L_p6_skip:
    s_cmp_ge_u32 s30, 2
    s_cselect_b32 s63, s101, s100
    s_mov_b32 s60, 0
LW_90:
    ds_read_b32 v14, v5
    s_add_u32 s60, s60, 1
    s_cmp_gt_u32 s60, 262144
    s_cbranch_scc1 LX_91
    s_waitcnt lgkmcnt(0)
    v_readfirstlane_b32 s31, v14
    s_cmp_lt_u32 s31, s63
    s_cbranch_scc1 LW_90
LX_91:
    s_waitcnt lgkmcnt(0)
    ds_read_b64_tr_b16 v[64:65], v12 offset:0
    ds_read_b64_tr_b16 v[66:67], v12 offset:256
    ds_read_b64_tr_b16 v[68:69], v12 offset:2048
    ds_read_b64_tr_b16 v[70:71], v12 offset:2304
    ds_read_b64_tr_b16 v[72:73], v12 offset:4096
    ds_read_b64_tr_b16 v[74:75], v12 offset:4352
    ds_read_b64_tr_b16 v[76:77], v12 offset:6144
    ds_read_b64_tr_b16 v[78:79], v12 offset:6400
    ds_read_b64_tr_b16 v[80:81], v12 offset:8192
    ds_read_b64_tr_b16 v[82:83], v12 offset:8448
    ds_read_b64_tr_b16 v[84:85], v12 offset:10240
    ds_read_b64_tr_b16 v[86:87], v12 offset:10496
    ds_read_b64_tr_b16 v[88:89], v12 offset:12288
    ds_read_b64_tr_b16 v[90:91], v12 offset:12544
    ds_read_b64_tr_b16 v[92:93], v12 offset:14336
    ds_read_b64_tr_b16 v[94:95], v12 offset:14592
    ds_read_b64_tr_b16 v[96:97], v12 offset:16384
    ds_read_b64_tr_b16 v[98:99], v12 offset:16640
    ds_read_b64_tr_b16 v[100:101], v12 offset:18432
    ds_read_b64_tr_b16 v[102:103], v12 offset:18688
    ds_read_b64_tr_b16 v[104:105], v12 offset:20480
    ds_read_b64_tr_b16 v[106:107], v12 offset:20736
    ds_read_b64_tr_b16 v[108:109], v12 offset:22528
    ds_read_b64_tr_b16 v[110:111], v12 offset:22784
    ds_read_b64_tr_b16 v[112:113], v12 offset:24576
    ds_read_b64_tr_b16 v[114:115], v12 offset:24832
    ds_read_b64_tr_b16 v[116:117], v12 offset:26624
    ds_read_b64_tr_b16 v[118:119], v12 offset:26880
    ds_read_b64_tr_b16 v[120:121], v12 offset:28672
    ds_read_b64_tr_b16 v[122:123], v12 offset:28928
    ds_read_b64_tr_b16 v[124:125], v12 offset:30720
    ds_read_b64_tr_b16 v[126:127], v12 offset:30976
    ds_read_b64_tr_b16 v[128:129], v12 offset:32768
    ds_read_b64_tr_b16 v[130:131], v12 offset:33024
    ds_read_b64_tr_b16 v[132:133], v12 offset:34816
    ds_read_b64_tr_b16 v[134:135], v12 offset:35072
    s_cmp_lg_u32 s53, 10
    s_cbranch_scc1 DFA_92
    s_mov_b32 s60, 0
LW_93:
    ds_read_b32 v14, v5
    s_add_u32 s60, s60, 1
    s_cmp_gt_u32 s60, 262144
    s_cbranch_scc1 LX_94
    s_waitcnt lgkmcnt(0)
    v_readfirstlane_b32 s31, v14
    s_cmp_lt_u32 s31, s53
    s_cbranch_scc1 LW_93
LX_94:
    s_waitcnt lgkmcnt(0)
    ds_read_b64_tr_b16 v[208:209], v10 offset:0
    ds_read_b64_tr_b16 v[210:211], v10 offset:4608
    ds_read_b64_tr_b16 v[212:213], v10 offset:32
    ds_read_b64_tr_b16 v[214:215], v10 offset:4640
    ds_read_b64_tr_b16 v[216:217], v10 offset:64
    ds_read_b64_tr_b16 v[218:219], v10 offset:4672
    ds_read_b64_tr_b16 v[220:221], v10 offset:96
    ds_read_b64_tr_b16 v[222:223], v10 offset:4704
    ds_read_b64_tr_b16 v[224:225], v10 offset:128
    ds_read_b64_tr_b16 v[226:227], v10 offset:4736
    ds_read_b64_tr_b16 v[228:229], v10 offset:160
    ds_read_b64_tr_b16 v[230:231], v10 offset:4768
    ds_read_b64_tr_b16 v[232:233], v10 offset:192
    ds_read_b64_tr_b16 v[234:235], v10 offset:4800
    ds_read_b64_tr_b16 v[236:237], v10 offset:224
    ds_read_b64_tr_b16 v[238:239], v10 offset:4832
    ds_read_b64_tr_b16 v[240:241], v10 offset:256
    ds_read_b64_tr_b16 v[242:243], v10 offset:4864
    ds_read_b64_tr_b16 v[244:245], v10 offset:288
    ds_read_b64_tr_b16 v[246:247], v10 offset:4896
DFA_92:
    s_mov_b32 s60, 0
LW_95:
    ds_read_b32 v14, v5 offset:20
    s_add_u32 s60, s60, 1
    s_cmp_gt_u32 s60, 262144
    s_cbranch_scc1 LX_96
    s_waitcnt lgkmcnt(0)
    v_readfirstlane_b32 s31, v14
    s_cmp_lt_u32 s31, 1
    s_cbranch_scc1 LW_95
LX_96:
    s_waitcnt lgkmcnt(0)
L_p7_go:
    v_lshlrev_b32 v13, 4, v3
    v_add_u32 v13, 156352, v13
    s_waitcnt lgkmcnt(0)
    ds_read_b128 v[136:139], v13 offset:0
    ds_read_b128 v[140:143], v13 offset:64
    ds_read_b128 v[144:147], v13 offset:128
    ds_read_b128 v[148:151], v13 offset:192
    ds_read_b128 v[152:155], v13 offset:256
    ds_read_b128 v[156:159], v13 offset:320
    ds_read_b128 v[160:163], v13 offset:384
    ds_read_b128 v[164:167], v13 offset:448
    ds_read_b128 v[168:171], v13 offset:512
    ds_read_b128 v[172:175], v13 offset:576
    ds_read_b128 v[176:179], v13 offset:640
    ds_read_b128 v[180:183], v13 offset:704
    ds_read_b128 v[184:187], v13 offset:768
    ds_read_b128 v[188:191], v13 offset:832
    s_waitcnt lgkmcnt(13)
    v_mfma_f32_16x16x32_bf16 v[20:23], v[64:67], v[136:139], 0
    ds_read_b128 v[192:195], v13 offset:896
    s_waitcnt lgkmcnt(13)
    v_mfma_f32_16x16x32_bf16 v[24:27], v[68:71], v[140:143], 0
    ds_read_b128 v[196:199], v13 offset:960
    s_waitcnt lgkmcnt(13)
    v_mfma_f32_16x16x32_bf16 v[20:23], v[72:75], v[144:147], v[20:23]
    ds_read_b128 v[200:203], v13 offset:1024
    s_waitcnt lgkmcnt(13)
    v_mfma_f32_16x16x32_bf16 v[24:27], v[76:79], v[148:151], v[24:27]
    ds_read_b128 v[204:207], v13 offset:1088
    s_waitcnt lgkmcnt(13)
    v_mfma_f32_16x16x32_bf16 v[20:23], v[80:83], v[152:155], v[20:23]
    s_waitcnt lgkmcnt(12)
    v_mfma_f32_16x16x32_bf16 v[24:27], v[84:87], v[156:159], v[24:27]
    s_waitcnt lgkmcnt(11)
    v_mfma_f32_16x16x32_bf16 v[20:23], v[88:91], v[160:163], v[20:23]
    s_waitcnt lgkmcnt(10)
    v_mfma_f32_16x16x32_bf16 v[24:27], v[92:95], v[164:167], v[24:27]
    s_waitcnt lgkmcnt(9)
    v_mfma_f32_16x16x32_bf16 v[20:23], v[96:99], v[168:171], v[20:23]
    s_waitcnt lgkmcnt(8)
    v_mfma_f32_16x16x32_bf16 v[24:27], v[100:103], v[172:175], v[24:27]
    s_waitcnt lgkmcnt(7)
    v_mfma_f32_16x16x32_bf16 v[20:23], v[104:107], v[176:179], v[20:23]
    s_waitcnt lgkmcnt(6)
    v_mfma_f32_16x16x32_bf16 v[24:27], v[108:111], v[180:183], v[24:27]
    s_waitcnt lgkmcnt(5)
    v_mfma_f32_16x16x32_bf16 v[20:23], v[112:115], v[184:187], v[20:23]
    s_waitcnt lgkmcnt(4)
    v_mfma_f32_16x16x32_bf16 v[24:27], v[116:119], v[188:191], v[24:27]
    s_waitcnt lgkmcnt(3)
    v_mfma_f32_16x16x32_bf16 v[20:23], v[120:123], v[192:195], v[20:23]
    s_waitcnt lgkmcnt(2)
    v_mfma_f32_16x16x32_bf16 v[24:27], v[124:127], v[196:199], v[24:27]
    s_waitcnt lgkmcnt(1)
    v_mfma_f32_16x16x32_bf16 v[20:23], v[128:131], v[200:203], v[20:23]
    s_waitcnt lgkmcnt(0)
    v_mfma_f32_16x16x32_bf16 v[24:27], v[132:135], v[204:207], v[24:27]
    s_lshl_b32 s40, s30, 6
    s_add_u32 s40, s40, 157504
    v_lshlrev_b32 v12, 4, v3
    v_add_u32 v12, s40, v12
    v_lshlrev_b32 v13, 5, v3
    v_add_u32 v13, 157504, v13
    s_mul_i32 s40, s28, 9
    s_add_u32 s40, s40, s29
    s_mul_i32 s40, s40, 2304
    s_mul_i32 s41, s30, 640
    s_add_u32 s40, s40, s41
    s_add_u32 s40, s40, 262144
    s_cmp_eq_u32 s30, 3
    s_cselect_b32 s41, 128, 0
    s_sub_u32 s40, s40, s41
    s_add_u32 s42, s26, s40
    s_addc_u32 s43, s27, 0
    v_add_f32 v20, v20, v24
    v_add_f32 v21, v21, v25
    v_add_f32 v22, v22, v26
    v_add_f32 v23, v23, v27
    s_mov_b32 exec_lo, 0x10001
    s_mov_b32 exec_hi, 0x10001
    ds_write_b128 v12, v[20:23]
    s_mov_b64 exec, -1
    s_cmp_eq_u32 s30, 0
    s_cbranch_scc1 DFC_98
    s_cmp_eq_u32 s53, 10
    s_cbranch_scc1 DFB_97
DFC_98:
    s_mov_b32 s60, 0
LW_99:
    ds_read_b32 v14, v5
    s_add_u32 s60, s60, 1
    s_cmp_gt_u32 s60, 262144
    s_cbranch_scc1 LX_100
    s_waitcnt lgkmcnt(0)
    v_readfirstlane_b32 s31, v14
    s_cmp_lt_u32 s31, s53
    s_cbranch_scc1 LW_99
LX_100:
    s_waitcnt lgkmcnt(0)
    ds_read_b64_tr_b16 v[208:209], v10 offset:0
    ds_read_b64_tr_b16 v[210:211], v10 offset:4608
    ds_read_b64_tr_b16 v[212:213], v10 offset:32
    ds_read_b64_tr_b16 v[214:215], v10 offset:4640
    ds_read_b64_tr_b16 v[216:217], v10 offset:64
    ds_read_b64_tr_b16 v[218:219], v10 offset:4672
    ds_read_b64_tr_b16 v[220:221], v10 offset:96
    ds_read_b64_tr_b16 v[222:223], v10 offset:4704
    ds_read_b64_tr_b16 v[224:225], v10 offset:128
    ds_read_b64_tr_b16 v[226:227], v10 offset:4736
    ds_read_b64_tr_b16 v[228:229], v10 offset:160
    ds_read_b64_tr_b16 v[230:231], v10 offset:4768
    ds_read_b64_tr_b16 v[232:233], v10 offset:192
    ds_read_b64_tr_b16 v[234:235], v10 offset:4800
    ds_read_b64_tr_b16 v[236:237], v10 offset:224
    ds_read_b64_tr_b16 v[238:239], v10 offset:4832
    ds_read_b64_tr_b16 v[240:241], v10 offset:256
    ds_read_b64_tr_b16 v[242:243], v10 offset:4864
    ds_read_b64_tr_b16 v[244:245], v10 offset:288
    ds_read_b64_tr_b16 v[246:247], v10 offset:4896
DFB_97:
    v_lshlrev_b32 v12, 6, v2
    v_lshl_add_u32 v12, v3, 4, v12
    s_mov_b32 s60, 0
R7_101:
    ds_read_b128 v[32:35], v13
    ds_read_b128 v[36:39], v13 offset:16
    ds_read_b128 v[40:43], v13 offset:128
    ds_read_b128 v[44:47], v13 offset:144
    s_add_u32 s60, s60, 1
    s_cmp_gt_u32 s60, 262144
    s_cbranch_scc1 R7X_102
    s_waitcnt lgkmcnt(0)
    v_max_f32 v48, 0, v32
    v_max_f32 v49, 0, v33
    v_max_f32 v50, 0, v34
    v_max_f32 v51, 0, v35
    v_max_f32 v52, 0, v36
    v_max_f32 v53, 0, v37
    v_max_f32 v54, 0, v38
    v_max_f32 v55, 0, v39
    v_pk_mul_f32 v[48:49], v[48:49], v[40:41]
    v_pk_mul_f32 v[50:51], v[50:51], v[42:43]
    v_pk_mul_f32 v[52:53], v[52:53], v[44:45]
    v_pk_mul_f32 v[54:55], v[54:55], v[46:47]
    v_max3_u32 v56, v32, v33, v34
    v_max3_u32 v57, v35, v36, v37
    v_max3_u32 v56, v56, v38, v39
    v_max3_u32 v57, v57, v40, v41
    v_max3_u32 v56, v56, v42, v43
    v_max3_u32 v57, v57, v44, v45
    v_max3_u32 v56, v56, v46, v47
    v_max_u32 v56, v56, v57
    v_cmp_eq_u32 vcc, -1, v56
    s_cbranch_vccnz R7_101
R7X_102:
    s_waitcnt lgkmcnt(0)
    v_cvt_pk_bf16_f32 v32, v48, v49
    v_cvt_pk_bf16_f32 v33, v50, v51
    v_cvt_pk_bf16_f32 v34, v52, v53
    v_cvt_pk_bf16_f32 v35, v54, v55
    v_and_b32 v136, v32, v6
    v_and_b32 v137, v33, v6
    v_and_b32 v138, v34, v6
    v_and_b32 v139, v35, v6
    v_and_b32 v140, v32, v7
    v_and_b32 v141, v33, v7
    v_and_b32 v142, v34, v7
    v_and_b32 v143, v35, v7
    v_mfma_f32_16x16x32_bf16 v[20:23], v[208:211], v[136:139], 0
    v_and_b32 v144, v32, v8
    v_and_b32 v145, v33, v8
    v_and_b32 v146, v34, v8
    v_and_b32 v147, v35, v8
    v_mfma_f32_16x16x32_bf16 v[20:23], v[212:215], v[140:143], v[20:23]
    v_and_b32 v148, v32, v30
    v_and_b32 v149, v33, v30
    v_and_b32 v150, v34, v30
    v_and_b32 v151, v35, v30
    v_mfma_f32_16x16x32_bf16 v[20:23], v[216:219], v[144:147], v[20:23]
    v_and_b32 v152, v32, v31
    v_and_b32 v153, v33, v31
    v_and_b32 v154, v34, v31
    v_and_b32 v155, v35, v31
    v_mfma_f32_16x16x32_bf16 v[20:23], v[220:223], v[148:151], v[20:23]
    v_and_b32 v156, v32, v60
    v_and_b32 v157, v33, v60
    v_and_b32 v158, v34, v60
    v_and_b32 v159, v35, v60
    v_mfma_f32_16x16x32_bf16 v[20:23], v[224:227], v[152:155], v[20:23]
    v_and_b32 v160, v32, v61
    v_and_b32 v161, v33, v61
    v_and_b32 v162, v34, v61
    v_and_b32 v163, v35, v61
    v_mfma_f32_16x16x32_bf16 v[20:23], v[228:231], v[156:159], v[20:23]
    v_and_b32 v164, v32, v62
    v_and_b32 v165, v33, v62
    v_and_b32 v166, v34, v62
    v_and_b32 v167, v35, v62
    v_mfma_f32_16x16x32_bf16 v[20:23], v[232:235], v[160:163], v[20:23]
    v_and_b32 v168, v32, v63
    v_and_b32 v169, v33, v63
    v_and_b32 v170, v34, v63
    v_and_b32 v171, v35, v63
    v_mfma_f32_16x16x32_bf16 v[20:23], v[236:239], v[164:167], v[20:23]
    v_and_b32 v172, v32, v0
    v_and_b32 v173, v33, v0
    v_and_b32 v174, v34, v0
    v_and_b32 v175, v35, v0
    v_mfma_f32_16x16x32_bf16 v[20:23], v[240:243], v[168:171], v[20:23]
    s_nop 1
    v_mfma_f32_16x16x32_bf16 v[20:23], v[244:247], v[172:175], v[20:23]
    s_nop 7
    v_and_or_b32 v20, v20, s57, v11
    v_and_or_b32 v21, v21, s57, v11
    v_and_or_b32 v22, v22, s57, v11
    v_and_or_b32 v23, v23, s57, v11
    s_mov_b32 s40, 0x03ff03ff
    s_cmp_ge_u32 s30, 2
    s_cselect_b32 s40, 0x00ff00ff, s40
    s_mov_b32 exec_lo, s40
    s_mov_b32 exec_hi, s40
    global_store_dwordx4 v12, v[20:23], s[42:43] sc1
    s_mov_b64 exec, -1
L_fin:
    s_endpgm
L_exit:
    s_endpgm
.section .rodata,"a"
.p2align 6
.amdhsa_kernel sequential_preLN__sliding_block_cached__glu_gated_reglu__decode_kernel
  .amdhsa_next_free_vgpr 256
  .amdhsa_next_free_sgpr 102
  .amdhsa_accum_offset 256
  .amdhsa_group_segment_fixed_size 0
  .amdhsa_kernarg_size 96
  .amdhsa_user_sgpr_count 2
  .amdhsa_user_sgpr_kernarg_segment_ptr 1
  .amdhsa_system_sgpr_workgroup_id_x 1
.end_amdhsa_kernel
```
